```python
import torch

def _softmax(x, axis=-1):
    return torch.softmax(x, dim=axis)
def _gelu(x):
    return torch.nn.functional.gelu(x, approximate="tanh")
def _silu(x):
    return torch.nn.functional.silu(x)
def _sigmoid(x):
    return torch.sigmoid(x)
def _layernorm(x, axis=-1, eps=1e-5):
    m = x.mean(dim=axis, keepdim=True)
    v = x.var(dim=axis, keepdim=True, unbiased=False)
    return (x - m) / torch.sqrt(v + eps)
def _scatter_add(tgt, idx, src, axis=0):
    return tgt.clone().index_add_(axis, idx, src)
def _segment_sum(src, seg, n):
    out = torch.zeros((n,) + src.shape[1:], dtype=src.dtype)
    return out.index_add_(0, seg, src)
def _pad(x, pw):
    flat = tuple(v for pair in reversed(pw) for v in pair)
    return torch.nn.functional.pad(x, flat)

kernel_name = 'sequential_preLN__spectral_fnet__dense_activation_squared_relu__prompt'

def setup_inputs():

    _w = (lambda a: (lambda t: t.to(torch.bfloat16) if t.is_floating_point() else t)(torch.as_tensor(a)))
    def _A_setup():
        B, S, D = 1, 2048, 640
        ns = torch.arange(S)[:, None] * torch.arange(S)[None, :]
        nd = torch.arange(D)[:, None] * torch.arange(D)[None, :]
        Ws_re = torch.cos(-2.0 * torch.pi * ns / S).to(float)
        Ws_im = torch.sin(-2.0 * torch.pi * ns / S).to(float)
        Wd_re = torch.cos(-2.0 * torch.pi * nd / D).to(float)
        Wd_im = torch.sin(-2.0 * torch.pi * nd / D).to(float)
        return {
            "x": _w((lambda *s: torch.randn(*s, dtype=torch.bfloat16) * 0.05)(B, S, D)),
            "dft_seq_re": _w(Ws_re),
            "dft_seq_im": _w(Ws_im),
            "dft_hid_re": _w(Wd_re),
            "dft_hid_im": _w(Wd_im),
        }
    _A_in = _A_setup()

    def _B_setup():
        B, S, D, F = 1, 2048, 640, 1728
        return {
            "x": _w((lambda *s: torch.randn(*s, dtype=torch.bfloat16) * 0.05)(B, S, D)),
            "w1": _w((lambda *s: torch.randn(*s, dtype=torch.bfloat16) * 0.2)(D, F)),
            "b1": _w((lambda *s: torch.randn(*s, dtype=torch.bfloat16) * 0.2)(F)),
            "w2": _w((lambda *s: torch.randn(*s, dtype=torch.bfloat16) * 0.2)(F, D)),
            "b2": _w((lambda *s: torch.randn(*s, dtype=torch.bfloat16) * 0.2)(D)),
        }
    _B_in = _B_setup()

    return {
        "A_x": _A_in["x"],
        "A_dft_seq_re": _A_in["dft_seq_re"],
        "A_dft_seq_im": _A_in["dft_seq_im"],
        "A_dft_hid_re": _A_in["dft_hid_re"],
        "A_dft_hid_im": _A_in["dft_hid_im"],
        "B_x": _B_in["x"],
        "B_w1": _B_in["w1"],
        "B_b1": _B_in["b1"],
        "B_w2": _B_in["w2"],
        "B_b2": _B_in["b2"],
    }

def reference(A_x, A_dft_seq_re, A_dft_seq_im, A_dft_hid_re, A_dft_hid_im, B_x, B_w1, B_b1, B_w2, B_b2):
    def _A_ref(x, dft_seq_re, dft_seq_im, dft_hid_re, dft_hid_im):
        a = torch.einsum("bsd,ed->bse", x, dft_hid_re)
        b = torch.einsum("bsd,ed->bse", x, dft_hid_im)
        y = torch.einsum("ts,bse->bte", dft_seq_re, a) - torch.einsum("ts,bse->bte", dft_seq_im, b)
        return y

    def _B_ref(x, w1, b1, w2, b2):
        h = torch.einsum("bsd,df->bsf", x, w1) + b1
        zero = torch.zeros_like(h)
        r = torch.where(h > zero, h, zero)
        h = r * r
        out = torch.einsum("bsf,fd->bsd", h, w2) + b2
        return out

    x = A_x
    h = x + _A_ref(_layernorm(x, axis=-1), A_dft_seq_re, A_dft_seq_im, A_dft_hid_re, A_dft_hid_im)
    h2 = h + _B_ref(_layernorm(h, axis=-1), B_w1, B_b1, B_w2, B_b2)
    return h2
```

```asm
; @launch grid=(256,1,1) block=(256,1,1) lds=163840
.amdgcn_target "amdgcn-amd-amdhsa--gfx950"
.text
.globl sequential_preLN__spectral_fnet__dense_activation_squared_relu__prompt_kernel
.p2align 8
.type sequential_preLN__spectral_fnet__dense_activation_squared_relu__prompt_kernel,@function
sequential_preLN__spectral_fnet__dense_activation_squared_relu__prompt_kernel:
    s_load_dwordx2 s[4:5], s[0:1], 0
    s_load_dwordx2 s[6:7], s[0:1], 96
    s_load_dwordx8 s[8:15], s[0:1], 48
    s_load_dwordx2 s[16:17], s[0:1], 80
    s_lshr_b32 s19, s2, 3
    s_cmp_ge_u32 s19, 32
    s_cbranch_scc1 L_end
    v_lshrrev_b32 v1, 6, v0
    s_and_b32 s18, s2, 7
    v_readfirstlane_b32 s3, v1
    s_getpc_b64 s[24:25]
L_pc:
    s_cmp_ge_u32 s19, (L_text_end-L_pc)/4096
    s_cbranch_scc1 L_nopf
    s_lshl_b32 s26, s19, 12
    v_lshl_add_u32 v1, v0, 4, s26
    global_load_dwordx4 a[252:255], v1, s[24:25]
L_nopf:
    v_and_b32 v0, 63, v0
    s_sub_u32 s19, s19, 1
    s_cmp_ge_u32 s19, 20
    s_cbranch_scc1 L1_relayout
    s_and_b32 s24, s19, 3
    s_lshl_b32 s18, s18, 2
    s_add_u32 s18, s18, s24
    s_lshr_b32 s24, s18, 1
    s_sub_u32 s25, 32, s24
    s_cmp_eq_u32 s18, 1
    s_cselect_b32 s25, 16, s25
    s_and_b32 s18, s18, 1
    s_cselect_b32 s18, s25, s24
    s_lshr_b32 s19, s19, 2
    v_lshrrev_b32 v1, 4, v0
    v_and_b32 v2, 15, v0
    s_lshl_b32 s26, s3, 9
    s_add_u32 s26, s26, s18
    s_mul_i32 s26, s26, 1280
    v_mul_u32_u24 v3, 40960, v1
    v_xor_b32 v237, v2, v1
    v_lshl_add_u32 v4, v237, 4, v3
    v_xor_b32 v238, 4, v237
    v_lshl_add_u32 v5, v238, 4, v3
    v_add_u32 v5, 162816, v5
    v_xor_b32 v238, 8, v237
    v_lshl_add_u32 v6, v238, 4, v3
    v_add_u32 v6, 325632, v6
    v_xor_b32 v238, 12, v237
    v_lshl_add_u32 v7, v238, 4, v3
    v_add_u32 v7, 488448, v7
    s_mul_i32 s27, s3, 20480
    s_lshl_b32 s24, s19, 8
    s_add_u32 s60, s26, s24
    s_mov_b32 s58, 0x280000
    s_mov_b32 s59, 0x20000
    s_mov_b32 m0, s27
    s_waitcnt lgkmcnt(0)
    s_mov_b64 s[56:57], s[4:5]
    buffer_load_dwordx4 v4, s[56:59], s60 offen offset:0 lds
    buffer_load_dwordx4 v5, s[56:59], s60 offen offset:1024 lds
    buffer_load_dwordx4 v6, s[56:59], s60 offen offset:2048 lds
    buffer_load_dwordx4 v7, s[56:59], s60 offen offset:3072 lds
    s_add_u32 s46, s6, 0x6e4000
    s_addc_u32 s47, s7, 0
    s_load_dword s55, s[46:47], 0
    s_mov_b32 s54, 0x8000
    s_cmp_ge_u32 s19, 4
    s_cselect_b32 s24, 1280, 0
    s_sub_u32 s24, s60, s24
    s_add_u32 s61, s24, 256
    s_cmp_ge_u32 s19, 3
    s_cselect_b32 s24, 1280, 0
    s_sub_u32 s24, s60, s24
    s_add_u32 s62, s24, 512
    s_cmp_ge_u32 s19, 2
    s_cselect_b32 s24, 1280, 0
    s_sub_u32 s24, s60, s24
    s_add_u32 s63, s24, 768
    s_cmp_ge_u32 s19, 1
    s_cselect_b32 s24, 1280, 0
    s_sub_u32 s24, s60, s24
    s_add_u32 s64, s24, 1024
    s_lshl_b32 s24, s19, 6
    s_lshl_b32 s25, s3, 4
    s_add_u32 s24, s24, s25
    v_add_u32 v3, s24, v2
    v_mov_b32 v237, 320
    v_cmp_eq_u32 vcc, 0, v3
    s_nop 1
    v_cndmask_b32 v237, v3, v237, vcc
    v_lshlrev_b32 v232, 31, v237
    v_or_b32 v232, 1.0, v232
    v_cvt_f32_u32 v233, v237
    v_mul_f32 v233, 0x3acccccd, v233
    v_cos_f32 v234, v233
    v_cvt_f32_u32 v236, v1
    v_mul_f32 v236, 0x41800000, v236
    s_lshl_b32 s24, s19, 7
    v_cvt_f32_u32 v237, s24
    v_add_f32 v236, v236, v237
    v_add_f32 v234, v234, v234
    v_sub_f32 v235, 0, v234
    v_add_f32 v241, 0x43a00000, v236
    v_mul_f32 v241, v241, v233
    v_fract_f32 v241, v241
    v_add_f32 v242, v241, v233
    v_cos_f32 v237, v241
    v_cos_f32 v238, v242
    v_sin_f32 v239, v241
    v_sin_f32 v240, v242
    v_cvt_pk_bf16_f32 v24, v237, v238
    v_cvt_pk_bf16_f32 v64, -v239, -v240
    v_fmac_f32 v237, v235, v238
    v_fmac_f32 v239, v235, v240
    v_fmac_f32 v238, v234, v237
    v_fmac_f32 v240, v234, v239
    v_cvt_pk_bf16_f32 v25, -v237, -v238
    v_cvt_pk_bf16_f32 v65, v239, v240
    v_fmac_f32 v237, v235, v238
    v_fmac_f32 v239, v235, v240
    v_fmac_f32 v238, v234, v237
    v_fmac_f32 v240, v234, v239
    v_cvt_pk_bf16_f32 v26, v237, v238
    v_cvt_pk_bf16_f32 v66, -v239, -v240
    v_fmac_f32 v237, v235, v238
    v_fmac_f32 v239, v235, v240
    v_fmac_f32 v238, v234, v237
    v_fmac_f32 v240, v234, v239
    v_cvt_pk_bf16_f32 v27, -v237, -v238
    v_cvt_pk_bf16_f32 v67, v239, v240
    v_fmac_f32 v237, v235, v238
    v_fmac_f32 v239, v235, v240
    v_fmac_f32 v238, v234, v237
    v_fmac_f32 v240, v234, v239
    v_cvt_pk_bf16_f32 v28, v237, v238
    v_cvt_pk_bf16_f32 v68, -v239, -v240
    v_fmac_f32 v237, v235, v238
    v_fmac_f32 v239, v235, v240
    v_fmac_f32 v238, v234, v237
    v_fmac_f32 v240, v234, v239
    v_cvt_pk_bf16_f32 v29, -v237, -v238
    v_cvt_pk_bf16_f32 v69, v239, v240
    v_fmac_f32 v237, v235, v238
    v_fmac_f32 v239, v235, v240
    v_fmac_f32 v238, v234, v237
    v_fmac_f32 v240, v234, v239
    v_cvt_pk_bf16_f32 v30, v237, v238
    v_cvt_pk_bf16_f32 v70, -v239, -v240
    v_fmac_f32 v237, v235, v238
    v_fmac_f32 v239, v235, v240
    v_fmac_f32 v238, v234, v237
    v_fmac_f32 v240, v234, v239
    v_cvt_pk_bf16_f32 v31, -v237, -v238
    v_cvt_pk_bf16_f32 v71, v239, v240
    v_add_f32 v241, 0x43c00000, v236
    v_mul_f32 v241, v241, v233
    v_fract_f32 v241, v241
    v_add_f32 v242, v241, v233
    v_cos_f32 v237, v241
    v_cos_f32 v238, v242
    v_sin_f32 v239, v241
    v_sin_f32 v240, v242
    v_cvt_pk_bf16_f32 v32, v237, v238
    v_cvt_pk_bf16_f32 v72, -v239, -v240
    v_fmac_f32 v237, v235, v238
    v_fmac_f32 v239, v235, v240
    v_fmac_f32 v238, v234, v237
    v_fmac_f32 v240, v234, v239
    v_cvt_pk_bf16_f32 v33, -v237, -v238
    v_cvt_pk_bf16_f32 v73, v239, v240
    v_fmac_f32 v237, v235, v238
    v_fmac_f32 v239, v235, v240
    v_fmac_f32 v238, v234, v237
    v_fmac_f32 v240, v234, v239
    v_cvt_pk_bf16_f32 v34, v237, v238
    v_cvt_pk_bf16_f32 v74, -v239, -v240
    v_fmac_f32 v237, v235, v238
    v_fmac_f32 v239, v235, v240
    v_fmac_f32 v238, v234, v237
    v_fmac_f32 v240, v234, v239
    v_cvt_pk_bf16_f32 v35, -v237, -v238
    v_cvt_pk_bf16_f32 v75, v239, v240
    v_fmac_f32 v237, v235, v238
    v_fmac_f32 v239, v235, v240
    v_fmac_f32 v238, v234, v237
    v_fmac_f32 v240, v234, v239
    v_cvt_pk_bf16_f32 v36, v237, v238
    v_cvt_pk_bf16_f32 v76, -v239, -v240
    v_fmac_f32 v237, v235, v238
    v_fmac_f32 v239, v235, v240
    v_fmac_f32 v238, v234, v237
    v_fmac_f32 v240, v234, v239
    v_cvt_pk_bf16_f32 v37, -v237, -v238
    v_cvt_pk_bf16_f32 v77, v239, v240
    v_fmac_f32 v237, v235, v238
    v_fmac_f32 v239, v235, v240
    v_fmac_f32 v238, v234, v237
    v_fmac_f32 v240, v234, v239
    v_cvt_pk_bf16_f32 v38, v237, v238
    v_cvt_pk_bf16_f32 v78, -v239, -v240
    v_fmac_f32 v237, v235, v238
    v_fmac_f32 v239, v235, v240
    v_fmac_f32 v238, v234, v237
    v_fmac_f32 v240, v234, v239
    v_cvt_pk_bf16_f32 v39, -v237, -v238
    v_cvt_pk_bf16_f32 v79, v239, v240
    v_add_f32 v241, 0x43e00000, v236
    v_mul_f32 v241, v241, v233
    v_fract_f32 v241, v241
    v_add_f32 v242, v241, v233
    v_cos_f32 v237, v241
    v_cos_f32 v238, v242
    v_sin_f32 v239, v241
    v_sin_f32 v240, v242
    v_cvt_pk_bf16_f32 v40, v237, v238
    v_cvt_pk_bf16_f32 v80, -v239, -v240
    v_fmac_f32 v237, v235, v238
    v_fmac_f32 v239, v235, v240
    v_fmac_f32 v238, v234, v237
    v_fmac_f32 v240, v234, v239
    v_cvt_pk_bf16_f32 v41, -v237, -v238
    v_cvt_pk_bf16_f32 v81, v239, v240
    v_fmac_f32 v237, v235, v238
    v_fmac_f32 v239, v235, v240
    v_fmac_f32 v238, v234, v237
    v_fmac_f32 v240, v234, v239
    v_cvt_pk_bf16_f32 v42, v237, v238
    v_cvt_pk_bf16_f32 v82, -v239, -v240
    v_fmac_f32 v237, v235, v238
    v_fmac_f32 v239, v235, v240
    v_fmac_f32 v238, v234, v237
    v_fmac_f32 v240, v234, v239
    v_cvt_pk_bf16_f32 v43, -v237, -v238
    v_cvt_pk_bf16_f32 v83, v239, v240
    v_fmac_f32 v237, v235, v238
    v_fmac_f32 v239, v235, v240
    v_fmac_f32 v238, v234, v237
    v_fmac_f32 v240, v234, v239
    v_cvt_pk_bf16_f32 v44, v237, v238
    v_cvt_pk_bf16_f32 v84, -v239, -v240
    v_fmac_f32 v237, v235, v238
    v_fmac_f32 v239, v235, v240
    v_fmac_f32 v238, v234, v237
    v_fmac_f32 v240, v234, v239
    v_cvt_pk_bf16_f32 v45, -v237, -v238
    v_cvt_pk_bf16_f32 v85, v239, v240
    v_fmac_f32 v237, v235, v238
    v_fmac_f32 v239, v235, v240
    v_fmac_f32 v238, v234, v237
    v_fmac_f32 v240, v234, v239
    v_cvt_pk_bf16_f32 v46, v237, v238
    v_cvt_pk_bf16_f32 v86, -v239, -v240
    v_fmac_f32 v237, v235, v238
    v_fmac_f32 v239, v235, v240
    v_fmac_f32 v238, v234, v237
    v_fmac_f32 v240, v234, v239
    v_cvt_pk_bf16_f32 v47, -v237, -v238
    v_cvt_pk_bf16_f32 v87, v239, v240
    v_add_f32 v241, 0x44000000, v236
    v_mul_f32 v241, v241, v233
    v_fract_f32 v241, v241
    v_add_f32 v242, v241, v233
    v_cos_f32 v237, v241
    v_cos_f32 v238, v242
    v_sin_f32 v239, v241
    v_sin_f32 v240, v242
    v_cvt_pk_bf16_f32 v48, v237, v238
    v_cvt_pk_bf16_f32 v88, -v239, -v240
    v_fmac_f32 v237, v235, v238
    v_fmac_f32 v239, v235, v240
    v_fmac_f32 v238, v234, v237
    v_fmac_f32 v240, v234, v239
    v_cvt_pk_bf16_f32 v49, -v237, -v238
    v_cvt_pk_bf16_f32 v89, v239, v240
    v_fmac_f32 v237, v235, v238
    v_fmac_f32 v239, v235, v240
    v_fmac_f32 v238, v234, v237
    v_fmac_f32 v240, v234, v239
    v_cvt_pk_bf16_f32 v50, v237, v238
    v_cvt_pk_bf16_f32 v90, -v239, -v240
    v_fmac_f32 v237, v235, v238
    v_fmac_f32 v239, v235, v240
    v_fmac_f32 v238, v234, v237
    v_fmac_f32 v240, v234, v239
    v_cvt_pk_bf16_f32 v51, -v237, -v238
    v_cvt_pk_bf16_f32 v91, v239, v240
    v_fmac_f32 v237, v235, v238
    v_fmac_f32 v239, v235, v240
    v_fmac_f32 v238, v234, v237
    v_fmac_f32 v240, v234, v239
    v_cvt_pk_bf16_f32 v52, v237, v238
    v_cvt_pk_bf16_f32 v92, -v239, -v240
    v_fmac_f32 v237, v235, v238
    v_fmac_f32 v239, v235, v240
    v_fmac_f32 v238, v234, v237
    v_fmac_f32 v240, v234, v239
    v_cvt_pk_bf16_f32 v53, -v237, -v238
    v_cvt_pk_bf16_f32 v93, v239, v240
    v_fmac_f32 v237, v235, v238
    v_fmac_f32 v239, v235, v240
    v_fmac_f32 v238, v234, v237
    v_fmac_f32 v240, v234, v239
    v_cvt_pk_bf16_f32 v54, v237, v238
    v_cvt_pk_bf16_f32 v94, -v239, -v240
    v_fmac_f32 v237, v235, v238
    v_fmac_f32 v239, v235, v240
    v_fmac_f32 v238, v234, v237
    v_fmac_f32 v240, v234, v239
    v_cvt_pk_bf16_f32 v55, -v237, -v238
    v_cvt_pk_bf16_f32 v95, v239, v240
    v_add_f32 v241, 0x44100000, v236
    v_mul_f32 v241, v241, v233
    v_fract_f32 v241, v241
    v_add_f32 v242, v241, v233
    v_cos_f32 v237, v241
    v_cos_f32 v238, v242
    v_sin_f32 v239, v241
    v_sin_f32 v240, v242
    v_cvt_pk_bf16_f32 v56, v237, v238
    v_cvt_pk_bf16_f32 v96, -v239, -v240
    v_fmac_f32 v237, v235, v238
    v_fmac_f32 v239, v235, v240
    v_fmac_f32 v238, v234, v237
    v_fmac_f32 v240, v234, v239
    v_cvt_pk_bf16_f32 v57, -v237, -v238
    v_cvt_pk_bf16_f32 v97, v239, v240
    v_fmac_f32 v237, v235, v238
    v_fmac_f32 v239, v235, v240
    v_fmac_f32 v238, v234, v237
    v_fmac_f32 v240, v234, v239
    v_cvt_pk_bf16_f32 v58, v237, v238
    v_cvt_pk_bf16_f32 v98, -v239, -v240
    v_fmac_f32 v237, v235, v238
    v_fmac_f32 v239, v235, v240
    v_fmac_f32 v238, v234, v237
    v_fmac_f32 v240, v234, v239
    v_cvt_pk_bf16_f32 v59, -v237, -v238
    v_cvt_pk_bf16_f32 v99, v239, v240
    v_fmac_f32 v237, v235, v238
    v_fmac_f32 v239, v235, v240
    v_fmac_f32 v238, v234, v237
    v_fmac_f32 v240, v234, v239
    v_cvt_pk_bf16_f32 v60, v237, v238
    v_cvt_pk_bf16_f32 v100, -v239, -v240
    v_fmac_f32 v237, v235, v238
    v_fmac_f32 v239, v235, v240
    v_fmac_f32 v238, v234, v237
    v_fmac_f32 v240, v234, v239
    v_cvt_pk_bf16_f32 v61, -v237, -v238
    v_cvt_pk_bf16_f32 v101, v239, v240
    v_fmac_f32 v237, v235, v238
    v_fmac_f32 v239, v235, v240
    v_fmac_f32 v238, v234, v237
    v_fmac_f32 v240, v234, v239
    v_cvt_pk_bf16_f32 v62, v237, v238
    v_cvt_pk_bf16_f32 v102, -v239, -v240
    v_fmac_f32 v237, v235, v238
    v_fmac_f32 v239, v235, v240
    v_fmac_f32 v238, v234, v237
    v_fmac_f32 v240, v234, v239
    v_cvt_pk_bf16_f32 v63, -v237, -v238
    v_cvt_pk_bf16_f32 v103, v239, v240
    v_lshlrev_b32 v237, 1, v1
    v_xor_b32 v237, v237, v2
    v_lshlrev_b32 v237, 4, v237
    v_lshl_add_u32 v237, v2, 8, v237
    s_add_u32 s24, s3, 0
    s_and_b32 s24, s24, 3
    s_lshl_b32 s28, s24, 9
    s_lshl_b32 s32, s24, 6
    s_mul_i32 s24, s24, 20480
    v_add_u32 v8, s24, v237
    v_xor_b32 v9, 16, v8
    v_xor_b32 v10, 128, v8
    v_xor_b32 v11, 144, v8
    s_add_u32 s24, s3, 1
    s_and_b32 s24, s24, 3
    s_lshl_b32 s29, s24, 9
    s_lshl_b32 s33, s24, 6
    s_mul_i32 s24, s24, 20480
    v_add_u32 v12, s24, v237
    v_xor_b32 v13, 16, v12
    v_xor_b32 v14, 128, v12
    v_xor_b32 v15, 144, v12
    s_add_u32 s24, s3, 2
    s_and_b32 s24, s24, 3
    s_lshl_b32 s30, s24, 9
    s_lshl_b32 s34, s24, 6
    s_mul_i32 s24, s24, 20480
    v_add_u32 v16, s24, v237
    v_xor_b32 v17, 16, v16
    v_xor_b32 v18, 128, v16
    v_xor_b32 v19, 144, v16
    s_add_u32 s24, s3, 3
    s_and_b32 s24, s24, 3
    s_lshl_b32 s31, s24, 9
    s_lshl_b32 s35, s24, 6
    s_mul_i32 s24, s24, 20480
    v_add_u32 v20, s24, v237
    v_xor_b32 v21, 16, v20
    v_xor_b32 v22, 128, v20
    v_xor_b32 v23, 144, v20
    v_mov_b32 v244, 0x3f803f80
    v_mov_b32 v245, 0x3f803f80
    v_mov_b32 v246, 0x3f803f80
    v_mov_b32 v247, 0x3f803f80
    s_and_b32 s44, s2, 7
    s_lshr_b32 s45, s2, 3
    s_lshl_b32 s48, s44, 2
    s_lshr_b32 s24, s45, 3
    s_add_u32 s48, s48, s24
    s_and_b32 s49, s45, 7
    s_lshr_b32 s24, s48, 1
    s_sub_u32 s25, 32, s24
    s_cmp_eq_u32 s48, 1
    s_cselect_b32 s25, 16, s25
    s_and_b32 s48, s48, 1
    s_cselect_b32 s48, s25, s24
    s_sub_u32 s24, 64, s48
    s_cmp_eq_u32 s48, 0
    s_cselect_b32 s24, 32, s24
    s_cmp_lt_u32 s3, 2
    s_cselect_b32 s50, s48, s24
    s_and_b32 s51, s3, 1
    s_lshl_b32 s52, s51, 10
    s_add_u32 s52, s52, s50
    s_mul_i32 s52, s52, 1280
    s_lshl_b32 s53, s3, 10
    v_lshrrev_b32 v241, 2, v0
    v_lshrrev_b32 v242, 3, v0
    v_and_b32 v242, 6, v242
    s_movk_i32 s24, 0x78
    v_lshrrev_b32 v242, v242, s24
    v_xor_b32 v242, v242, v0
    v_and_b32 v242, 3, v242
    v_lshlrev_b32 v242, 4, v242
    s_mov_b32 s24, 81920
    v_mad_u32_u24 v243, v241, s24, v242
    s_mul_i32 s24, s18, 1280
    v_lshlrev_b32 v3, 2, v3
    v_add_u32 v3, s24, v3
    s_mov_b32 s24, 327680
    v_mad_u32_u24 v3, v1, s24, v3
    v_lshlrev_b32 v148, 7, v1
    v_add_u32 v148, s18, v148
    v_add_u32 v149, s28, v148
    v_cvt_f32_u32 v149, v149
    v_mul_f32 v136, 0x3a000000, v149
    v_add_f32 v137, 0x3c800000, v136
    v_add_f32 v138, 0x3d000000, v136
    v_add_f32 v139, 0x3d400000, v136
    v_add_u32 v149, s29, v148
    v_cvt_f32_u32 v149, v149
    v_mul_f32 v140, 0x3a000000, v149
    v_add_f32 v141, 0x3c800000, v140
    v_add_f32 v142, 0x3d000000, v140
    v_add_f32 v143, 0x3d400000, v140
    v_lshlrev_b32 v148, 1, v2
    v_cvt_f32_u32 v144, v148
    v_add_f32 v145, 0x42000000, v144
    v_add_f32 v146, 1.0, v144
    v_add_f32 v147, 0x42040000, v144
    v_mul_f32 v148, v144, v136
    v_mul_f32 v149, v144, v137
    v_cos_f32 v150, v148
    v_cos_f32 v151, v149
    v_sin_f32 v152, v148
    v_sin_f32 v153, v149
    v_cvt_pk_bf16_f32 v200, v150, v151
    v_cvt_pk_bf16_f32 v204, v152, v153
    v_mul_f32 v148, v144, v138
    v_mul_f32 v149, v144, v139
    v_cos_f32 v150, v148
    v_cos_f32 v151, v149
    v_sin_f32 v152, v148
    v_sin_f32 v153, v149
    v_cvt_pk_bf16_f32 v201, v150, v151
    v_cvt_pk_bf16_f32 v205, v152, v153
    v_mul_f32 v148, v144, v140
    v_mul_f32 v149, v144, v141
    v_cos_f32 v150, v148
    v_cos_f32 v151, v149
    v_sin_f32 v152, v148
    v_sin_f32 v153, v149
    v_cvt_pk_bf16_f32 v202, v150, v151
    v_cvt_pk_bf16_f32 v206, v152, v153
    v_mul_f32 v148, v144, v142
    v_mul_f32 v149, v144, v143
    v_cos_f32 v150, v148
    v_cos_f32 v151, v149
    v_sin_f32 v152, v148
    v_sin_f32 v153, v149
    v_cvt_pk_bf16_f32 v203, v150, v151
    v_cvt_pk_bf16_f32 v207, v152, v153
    v_mul_f32 v148, v145, v136
    v_mul_f32 v149, v145, v137
    v_cos_f32 v150, v148
    v_cos_f32 v151, v149
    v_sin_f32 v152, v148
    v_sin_f32 v153, v149
    v_cvt_pk_bf16_f32 v208, v150, v151
    v_cvt_pk_bf16_f32 v212, v152, v153
    v_mul_f32 v148, v145, v138
    v_mul_f32 v149, v145, v139
    v_cos_f32 v150, v148
    v_cos_f32 v151, v149
    v_sin_f32 v152, v148
    v_sin_f32 v153, v149
    v_cvt_pk_bf16_f32 v209, v150, v151
    v_cvt_pk_bf16_f32 v213, v152, v153
    v_mul_f32 v148, v145, v140
    v_mul_f32 v149, v145, v141
    v_cos_f32 v150, v148
    v_cos_f32 v151, v149
    v_sin_f32 v152, v148
    v_sin_f32 v153, v149
    v_cvt_pk_bf16_f32 v210, v150, v151
    v_cvt_pk_bf16_f32 v214, v152, v153
    v_mul_f32 v148, v145, v142
    v_mul_f32 v149, v145, v143
    v_cos_f32 v150, v148
    v_cos_f32 v151, v149
    v_sin_f32 v152, v148
    v_sin_f32 v153, v149
    v_cvt_pk_bf16_f32 v211, v150, v151
    v_cvt_pk_bf16_f32 v215, v152, v153
    v_mul_f32 v148, v146, v136
    v_mul_f32 v149, v146, v137
    v_cos_f32 v150, v148
    v_cos_f32 v151, v149
    v_sin_f32 v152, v148
    v_sin_f32 v153, v149
    v_cvt_pk_bf16_f32 v216, v150, v151
    v_cvt_pk_bf16_f32 v220, v152, v153
    v_mul_f32 v148, v146, v138
    v_mul_f32 v149, v146, v139
    v_cos_f32 v150, v148
    v_cos_f32 v151, v149
    v_sin_f32 v152, v148
    v_sin_f32 v153, v149
    v_cvt_pk_bf16_f32 v217, v150, v151
    v_cvt_pk_bf16_f32 v221, v152, v153
    v_mul_f32 v148, v146, v140
    v_mul_f32 v149, v146, v141
    v_cos_f32 v150, v148
    v_cos_f32 v151, v149
    v_sin_f32 v152, v148
    v_sin_f32 v153, v149
    v_cvt_pk_bf16_f32 v218, v150, v151
    v_cvt_pk_bf16_f32 v222, v152, v153
    v_mul_f32 v148, v146, v142
    v_mul_f32 v149, v146, v143
    v_cos_f32 v150, v148
    v_cos_f32 v151, v149
    v_sin_f32 v152, v148
    v_sin_f32 v153, v149
    v_cvt_pk_bf16_f32 v219, v150, v151
    v_cvt_pk_bf16_f32 v223, v152, v153
    v_mul_f32 v148, v147, v136
    v_mul_f32 v149, v147, v137
    v_cos_f32 v150, v148
    v_cos_f32 v151, v149
    v_sin_f32 v152, v148
    v_sin_f32 v153, v149
    v_cvt_pk_bf16_f32 v224, v150, v151
    v_cvt_pk_bf16_f32 v228, v152, v153
    v_mul_f32 v148, v147, v138
    v_mul_f32 v149, v147, v139
    v_cos_f32 v150, v148
    v_cos_f32 v151, v149
    v_sin_f32 v152, v148
    v_sin_f32 v153, v149
    v_cvt_pk_bf16_f32 v225, v150, v151
    v_cvt_pk_bf16_f32 v229, v152, v153
    v_mul_f32 v148, v147, v140
    v_mul_f32 v149, v147, v141
    v_cos_f32 v150, v148
    v_cos_f32 v151, v149
    v_sin_f32 v152, v148
    v_sin_f32 v153, v149
    v_cvt_pk_bf16_f32 v226, v150, v151
    v_cvt_pk_bf16_f32 v230, v152, v153
    v_mul_f32 v148, v147, v142
    v_mul_f32 v149, v147, v143
    v_cos_f32 v150, v148
    v_cos_f32 v151, v149
    v_sin_f32 v152, v148
    v_sin_f32 v153, v149
    v_cvt_pk_bf16_f32 v227, v150, v151
    v_cvt_pk_bf16_f32 v231, v152, v153
    v_and_b32 v238, 1, v2
    v_cmp_ne_u32 s[36:37], 0, v238
    v_and_b32 v238, 2, v2
    v_cmp_ne_u32 s[38:39], 0, v238
    v_lshrrev_b32 v238, 2, v2
    v_cmp_eq_u32 vcc, v238, v1
    v_lshlrev_b32 v238, 2, v2
    v_add_u32 v238, s32, v238
    v_mov_b32 v239, 256
    v_cndmask_b32 v233, v239, v238, vcc
    v_lshlrev_b32 v238, 4, v1
    v_add_u32 v234, s32, v238
    v_add_u32 v235, s33, v238
    v_add_u32 v236, s34, v238
    v_add_u32 v237, s35, v238
    s_waitcnt vmcnt(0)
    s_barrier
    s_add_u32 m0, s27, 4096
    s_nop 0
    buffer_load_dwordx4 v4, s[56:59], s61 offen offset:0 lds
    buffer_load_dwordx4 v5, s[56:59], s61 offen offset:1024 lds
    buffer_load_dwordx4 v6, s[56:59], s61 offen offset:2048 lds
    buffer_load_dwordx4 v7, s[56:59], s61 offen offset:3072 lds
    ds_read_b128 v[168:171], v8 offset:0
    s_add_u32 m0, s27, 8192
    s_nop 0
    buffer_load_dwordx4 v4, s[56:59], s62 offen offset:0 lds
    ds_read_b128 v[172:175], v12 offset:0
    ds_read_b128 v[176:179], v16 offset:0
    ds_read_b128 v[180:183], v20 offset:0
    ds_read_b128 v[184:187], v9 offset:0
    ds_read_b128 v[188:191], v13 offset:0
    s_waitcnt lgkmcnt(0)
    v_mfma_f32_16x16x32_bf16 v[248:251], v[168:171], v[168:171], 0
    ds_read_b128 v[192:195], v17 offset:0
    v_mfma_f32_16x16x32_bf16 v[252:255], v[168:171], v[244:247], 0
    buffer_load_dwordx4 v5, s[56:59], s62 offen offset:1024 lds
    v_mfma_f32_16x16x32_bf16 v[104:107], v[168:171], v[24:27], 0
    v_mfma_f32_16x16x32_bf16 v[120:123], v[168:171], v[64:67], 0
    buffer_load_dwordx4 v6, s[56:59], s62 offen offset:2048 lds
    v_mfma_f32_16x16x32_bf16 v[108:111], v[172:175], v[24:27], 0
    ds_read_b128 v[196:199], v21 offset:0
    v_mfma_f32_16x16x32_bf16 v[124:127], v[172:175], v[64:67], 0
    v_mfma_f32_16x16x32_bf16 v[112:115], v[176:179], v[24:27], 0
    ds_read_b128 v[168:171], v10 offset:0
    buffer_load_dwordx4 v7, s[56:59], s62 offen offset:3072 lds
    v_mfma_f32_16x16x32_bf16 v[128:131], v[176:179], v[64:67], 0
    s_add_u32 m0, s27, 12288
    v_mfma_f32_16x16x32_bf16 v[116:119], v[180:183], v[24:27], 0
    ds_read_b128 v[172:175], v14 offset:0
    buffer_load_dwordx4 v4, s[56:59], s63 offen offset:0 lds
    v_mfma_f32_16x16x32_bf16 v[132:135], v[180:183], v[64:67], 0
    v_mfma_f32_16x16x32_bf16 v[248:251], v[184:187], v[184:187], v[248:251]
    ds_read_b128 v[176:179], v18 offset:0
    v_mfma_f32_16x16x32_bf16 v[252:255], v[184:187], v[244:247], v[252:255]
    buffer_load_dwordx4 v5, s[56:59], s63 offen offset:1024 lds
    v_mfma_f32_16x16x32_bf16 v[104:107], v[184:187], v[28:31], v[104:107]
    v_mfma_f32_16x16x32_bf16 v[120:123], v[184:187], v[68:71], v[120:123]
    buffer_load_dwordx4 v6, s[56:59], s63 offen offset:2048 lds
    v_mfma_f32_16x16x32_bf16 v[108:111], v[188:191], v[28:31], v[108:111]
    ds_read_b128 v[180:183], v22 offset:0
    v_mfma_f32_16x16x32_bf16 v[124:127], v[188:191], v[68:71], v[124:127]
    s_waitcnt lgkmcnt(4)
    v_mfma_f32_16x16x32_bf16 v[112:115], v[192:195], v[28:31], v[112:115]
    ds_read_b128 v[184:187], v11 offset:0
    buffer_load_dwordx4 v7, s[56:59], s63 offen offset:3072 lds
    v_mfma_f32_16x16x32_bf16 v[128:131], v[192:195], v[68:71], v[128:131]
    s_add_u32 m0, s27, 16384
    v_mfma_f32_16x16x32_bf16 v[116:119], v[196:199], v[28:31], v[116:119]
    ds_read_b128 v[188:191], v15 offset:0
    buffer_load_dwordx4 v4, s[56:59], s64 offen offset:0 lds
    v_mfma_f32_16x16x32_bf16 v[132:135], v[196:199], v[68:71], v[132:135]
    s_waitcnt lgkmcnt(4)
    v_mfma_f32_16x16x32_bf16 v[248:251], v[168:171], v[168:171], v[248:251]
    ds_read_b128 v[192:195], v19 offset:0
    v_mfma_f32_16x16x32_bf16 v[252:255], v[168:171], v[244:247], v[252:255]
    buffer_load_dwordx4 v5, s[56:59], s64 offen offset:1024 lds
    v_mfma_f32_16x16x32_bf16 v[104:107], v[168:171], v[32:35], v[104:107]
    v_mfma_f32_16x16x32_bf16 v[120:123], v[168:171], v[72:75], v[120:123]
    buffer_load_dwordx4 v6, s[56:59], s64 offen offset:2048 lds
    v_mfma_f32_16x16x32_bf16 v[108:111], v[172:175], v[32:35], v[108:111]
    ds_read_b128 v[196:199], v23 offset:0
    v_mfma_f32_16x16x32_bf16 v[124:127], v[172:175], v[72:75], v[124:127]
    s_waitcnt lgkmcnt(4)
    v_mfma_f32_16x16x32_bf16 v[112:115], v[176:179], v[32:35], v[112:115]
    s_waitcnt vmcnt(11)
    s_barrier
    ds_read_b128 v[168:171], v8 offset:4096
    v_mfma_f32_16x16x32_bf16 v[128:131], v[176:179], v[72:75], v[128:131]
    buffer_load_dwordx4 v7, s[56:59], s64 offen offset:3072 lds
    v_mfma_f32_16x16x32_bf16 v[116:119], v[180:183], v[32:35], v[116:119]
    ds_read_b128 v[172:175], v12 offset:4096
    v_mfma_f32_16x16x32_bf16 v[132:135], v[180:183], v[72:75], v[132:135]
    s_waitcnt lgkmcnt(4)
    v_mfma_f32_16x16x32_bf16 v[248:251], v[184:187], v[184:187], v[248:251]
    ds_read_b128 v[176:179], v16 offset:4096
    v_mfma_f32_16x16x32_bf16 v[252:255], v[184:187], v[244:247], v[252:255]
    v_mfma_f32_16x16x32_bf16 v[104:107], v[184:187], v[36:39], v[104:107]
    v_mfma_f32_16x16x32_bf16 v[120:123], v[184:187], v[76:79], v[120:123]
    v_mfma_f32_16x16x32_bf16 v[108:111], v[188:191], v[36:39], v[108:111]
    ds_read_b128 v[180:183], v20 offset:4096
    v_mfma_f32_16x16x32_bf16 v[124:127], v[188:191], v[76:79], v[124:127]
    s_waitcnt lgkmcnt(4)
    v_mfma_f32_16x16x32_bf16 v[112:115], v[192:195], v[36:39], v[112:115]
    ds_read_b128 v[184:187], v9 offset:4096
    v_mfma_f32_16x16x32_bf16 v[128:131], v[192:195], v[76:79], v[128:131]
    v_mfma_f32_16x16x32_bf16 v[116:119], v[196:199], v[36:39], v[116:119]
    ds_read_b128 v[188:191], v13 offset:4096
    v_mfma_f32_16x16x32_bf16 v[132:135], v[196:199], v[76:79], v[132:135]
    s_waitcnt lgkmcnt(4)
    v_mfma_f32_16x16x32_bf16 v[248:251], v[168:171], v[168:171], v[248:251]
    ds_read_b128 v[192:195], v17 offset:4096
    v_add_u32 v136, 0, v3
    v_add_u32 v137, 81920, v3
    v_mfma_f32_16x16x32_bf16 v[252:255], v[168:171], v[244:247], v[252:255]
    v_add_u32 v138, 163840, v3
    v_add_u32 v139, 245760, v3
    v_mfma_f32_16x16x32_bf16 v[104:107], v[168:171], v[40:43], v[104:107]
    v_xor_b32 v152, 0x80008000, v204
    v_xor_b32 v153, 0x80008000, v205
    v_mfma_f32_16x16x32_bf16 v[120:123], v[168:171], v[80:83], v[120:123]
    v_xor_b32 v154, 0x80008000, v206
    v_xor_b32 v155, 0x80008000, v207
    v_mfma_f32_16x16x32_bf16 v[108:111], v[172:175], v[40:43], v[108:111]
    ds_read_b128 v[196:199], v21 offset:4096
    v_add_u32 v140, 1310720, v3
    v_add_u32 v141, 1392640, v3
    v_mfma_f32_16x16x32_bf16 v[124:127], v[172:175], v[80:83], v[124:127]
    v_add_u32 v142, 1474560, v3
    s_waitcnt lgkmcnt(4)
    v_mfma_f32_16x16x32_bf16 v[112:115], v[176:179], v[40:43], v[112:115]
    ds_read_b128 v[168:171], v10 offset:4096
    v_add_u32 v143, 1556480, v3
    v_xor_b32 v156, 0x80008000, v212
    v_mfma_f32_16x16x32_bf16 v[128:131], v[176:179], v[80:83], v[128:131]
    v_xor_b32 v157, 0x80008000, v213
    v_xor_b32 v158, 0x80008000, v214
    v_mfma_f32_16x16x32_bf16 v[116:119], v[180:183], v[40:43], v[116:119]
    ds_read_b128 v[172:175], v14 offset:4096
    v_xor_b32 v159, 0x80008000, v215
    v_add_u32 v144, 40960, v3
    v_mfma_f32_16x16x32_bf16 v[132:135], v[180:183], v[80:83], v[132:135]
    v_add_u32 v145, 122880, v3
    s_waitcnt lgkmcnt(4)
    v_mfma_f32_16x16x32_bf16 v[248:251], v[184:187], v[184:187], v[248:251]
    ds_read_b128 v[176:179], v18 offset:4096
    v_add_u32 v146, 204800, v3
    v_add_u32 v147, 286720, v3
    v_mfma_f32_16x16x32_bf16 v[252:255], v[184:187], v[244:247], v[252:255]
    v_xor_b32 v160, 0x80008000, v220
    v_xor_b32 v161, 0x80008000, v221
    v_mfma_f32_16x16x32_bf16 v[104:107], v[184:187], v[44:47], v[104:107]
    v_xor_b32 v162, 0x80008000, v222
    v_xor_b32 v163, 0x80008000, v223
    v_mfma_f32_16x16x32_bf16 v[120:123], v[184:187], v[84:87], v[120:123]
    v_add_u32 v148, 1351680, v3
    v_add_u32 v149, 1433600, v3
    v_mfma_f32_16x16x32_bf16 v[108:111], v[188:191], v[44:47], v[108:111]
    ds_read_b128 v[180:183], v22 offset:4096
    v_add_u32 v150, 1515520, v3
    v_add_u32 v151, 1597440, v3
    v_mfma_f32_16x16x32_bf16 v[124:127], v[188:191], v[84:87], v[124:127]
    v_xor_b32 v164, 0x80008000, v228
    s_waitcnt lgkmcnt(4)
    v_mfma_f32_16x16x32_bf16 v[112:115], v[192:195], v[44:47], v[112:115]
    ds_read_b128 v[184:187], v11 offset:4096
    v_xor_b32 v165, 0x80008000, v229
    v_xor_b32 v166, 0x80008000, v230
    v_mfma_f32_16x16x32_bf16 v[128:131], v[192:195], v[84:87], v[128:131]
    v_xor_b32 v167, 0x80008000, v231
    v_mfma_f32_16x16x32_bf16 v[116:119], v[196:199], v[44:47], v[116:119]
    ds_read_b128 v[188:191], v15 offset:4096
    v_mfma_f32_16x16x32_bf16 v[132:135], v[196:199], v[84:87], v[132:135]
    s_waitcnt lgkmcnt(4)
    v_mfma_f32_16x16x32_bf16 v[248:251], v[168:171], v[168:171], v[248:251]
    ds_read_b128 v[192:195], v19 offset:4096
    v_mfma_f32_16x16x32_bf16 v[252:255], v[168:171], v[244:247], v[252:255]
    v_mfma_f32_16x16x32_bf16 v[104:107], v[168:171], v[48:51], v[104:107]
    v_mfma_f32_16x16x32_bf16 v[120:123], v[168:171], v[88:91], v[120:123]
    v_mfma_f32_16x16x32_bf16 v[108:111], v[172:175], v[48:51], v[108:111]
    ds_read_b128 v[196:199], v23 offset:4096
    v_mfma_f32_16x16x32_bf16 v[124:127], v[172:175], v[88:91], v[124:127]
    s_waitcnt lgkmcnt(4)
    v_mfma_f32_16x16x32_bf16 v[112:115], v[176:179], v[48:51], v[112:115]
    s_waitcnt vmcnt(8)
    s_barrier
    ds_read_b128 v[168:171], v8 offset:8192
    v_mfma_f32_16x16x32_bf16 v[128:131], v[176:179], v[88:91], v[128:131]
    s_add_u32 m0, s53, 122880
    v_mfma_f32_16x16x32_bf16 v[116:119], v[180:183], v[48:51], v[116:119]
    ds_read_b128 v[172:175], v12 offset:8192
    buffer_load_dwordx4 v243, s[56:59], s52 offen offset:0 lds
    v_mfma_f32_16x16x32_bf16 v[132:135], v[180:183], v[88:91], v[132:135]
    s_waitcnt lgkmcnt(4)
    v_mfma_f32_16x16x32_bf16 v[248:251], v[184:187], v[184:187], v[248:251]
    ds_read_b128 v[176:179], v16 offset:8192
    v_mfma_f32_16x16x32_bf16 v[252:255], v[184:187], v[244:247], v[252:255]
    v_mfma_f32_16x16x32_bf16 v[104:107], v[184:187], v[52:55], v[104:107]
    s_add_u32 m0, s53, 126912
    v_mfma_f32_16x16x32_bf16 v[120:123], v[184:187], v[92:95], v[120:123]
    buffer_load_dwordx4 v243, s[56:59], s52 offen offset:64 lds
    v_mfma_f32_16x16x32_bf16 v[108:111], v[188:191], v[52:55], v[108:111]
    ds_read_b128 v[180:183], v20 offset:8192
    v_mfma_f32_16x16x32_bf16 v[124:127], v[188:191], v[92:95], v[124:127]
    s_waitcnt lgkmcnt(4)
    v_mfma_f32_16x16x32_bf16 v[112:115], v[192:195], v[52:55], v[112:115]
    ds_read_b128 v[184:187], v9 offset:8192
    v_mfma_f32_16x16x32_bf16 v[128:131], v[192:195], v[92:95], v[128:131]
    s_add_u32 m0, s53, 130944
    v_mfma_f32_16x16x32_bf16 v[116:119], v[196:199], v[52:55], v[116:119]
    ds_read_b128 v[188:191], v13 offset:8192
    buffer_load_dwordx4 v243, s[56:59], s52 offen offset:128 lds
    v_mfma_f32_16x16x32_bf16 v[132:135], v[196:199], v[92:95], v[132:135]
    s_waitcnt lgkmcnt(4)
    v_mfma_f32_16x16x32_bf16 v[248:251], v[168:171], v[168:171], v[248:251]
    ds_read_b128 v[192:195], v17 offset:8192
    v_mfma_f32_16x16x32_bf16 v[252:255], v[168:171], v[244:247], v[252:255]
    v_mfma_f32_16x16x32_bf16 v[104:107], v[168:171], v[56:59], v[104:107]
    s_add_u32 m0, s53, 134976
    v_mfma_f32_16x16x32_bf16 v[120:123], v[168:171], v[96:99], v[120:123]
    buffer_load_dwordx4 v243, s[56:59], s52 offen offset:192 lds
    v_mfma_f32_16x16x32_bf16 v[108:111], v[172:175], v[56:59], v[108:111]
    ds_read_b128 v[196:199], v21 offset:8192
    v_mfma_f32_16x16x32_bf16 v[124:127], v[172:175], v[96:99], v[124:127]
    s_waitcnt lgkmcnt(4)
    v_mfma_f32_16x16x32_bf16 v[112:115], v[176:179], v[56:59], v[112:115]
    ds_read_b128 v[168:171], v10 offset:8192
    v_mfma_f32_16x16x32_bf16 v[128:131], v[176:179], v[96:99], v[128:131]
    s_add_u32 m0, s53, 139008
    v_mfma_f32_16x16x32_bf16 v[116:119], v[180:183], v[56:59], v[116:119]
    ds_read_b128 v[172:175], v14 offset:8192
    buffer_load_dwordx4 v243, s[56:59], s52 offen offset:256 lds
    v_mfma_f32_16x16x32_bf16 v[132:135], v[180:183], v[96:99], v[132:135]
    s_waitcnt lgkmcnt(4)
    v_mfma_f32_16x16x32_bf16 v[248:251], v[184:187], v[184:187], v[248:251]
    ds_read_b128 v[176:179], v18 offset:8192
    v_mfma_f32_16x16x32_bf16 v[252:255], v[184:187], v[244:247], v[252:255]
    v_mfma_f32_16x16x32_bf16 v[104:107], v[184:187], v[60:63], v[104:107]
    s_add_u32 m0, s53, 143040
    v_mfma_f32_16x16x32_bf16 v[120:123], v[184:187], v[100:103], v[120:123]
    buffer_load_dwordx4 v243, s[56:59], s52 offen offset:320 lds
    v_mfma_f32_16x16x32_bf16 v[108:111], v[188:191], v[60:63], v[108:111]
    ds_read_b128 v[180:183], v22 offset:8192
    v_mfma_f32_16x16x32_bf16 v[124:127], v[188:191], v[100:103], v[124:127]
    s_waitcnt lgkmcnt(4)
    v_mfma_f32_16x16x32_bf16 v[112:115], v[192:195], v[60:63], v[112:115]
    ds_read_b128 v[184:187], v11 offset:8192
    v_mul_f32 v104, v232, v104
    v_mul_f32 v105, v232, v105
    v_mul_f32 v106, v232, v106
    v_mfma_f32_16x16x32_bf16 v[128:131], v[192:195], v[100:103], v[128:131]
    v_mul_f32 v107, v232, v107
    v_mul_f32 v120, v232, v120
    v_mul_f32 v121, v232, v121
    v_mfma_f32_16x16x32_bf16 v[116:119], v[196:199], v[60:63], v[116:119]
    ds_read_b128 v[188:191], v15 offset:8192
    v_mul_f32 v122, v232, v122
    v_mul_f32 v123, v232, v123
    v_mul_f32 v108, v232, v108
    v_mfma_f32_16x16x32_bf16 v[132:135], v[196:199], v[100:103], v[132:135]
    v_mul_f32 v109, v232, v109
    v_mul_f32 v110, v232, v110
    s_waitcnt lgkmcnt(4)
    v_mfma_f32_16x16x32_bf16 v[248:251], v[168:171], v[168:171], v[248:251]
    ds_read_b128 v[192:195], v19 offset:8192
    v_mul_f32 v111, v232, v111
    v_mul_f32 v124, v232, v124
    v_mul_f32 v125, v232, v125
    v_mfma_f32_16x16x32_bf16 v[252:255], v[168:171], v[244:247], v[252:255]
    v_mul_f32 v126, v232, v126
    v_mul_f32 v127, v232, v127
    v_mul_f32 v112, v232, v112
    v_mfma_f32_16x16x32_bf16 v[104:107], v[168:171], v[24:27], v[104:107]
    v_mul_f32 v113, v232, v113
    v_mul_f32 v114, v232, v114
    v_mul_f32 v115, v232, v115
    v_mfma_f32_16x16x32_bf16 v[120:123], v[168:171], v[64:67], v[120:123]
    v_mul_f32 v128, v232, v128
    v_mul_f32 v129, v232, v129
    v_mul_f32 v130, v232, v130
    v_mfma_f32_16x16x32_bf16 v[108:111], v[172:175], v[24:27], v[108:111]
    ds_read_b128 v[196:199], v23 offset:8192
    v_mul_f32 v131, v232, v131
    v_mul_f32 v116, v232, v116
    v_mul_f32 v117, v232, v117
    v_mfma_f32_16x16x32_bf16 v[124:127], v[172:175], v[64:67], v[124:127]
    v_mul_f32 v118, v232, v118
    v_mul_f32 v119, v232, v119
    s_waitcnt lgkmcnt(4)
    v_mfma_f32_16x16x32_bf16 v[112:115], v[176:179], v[24:27], v[112:115]
    s_waitcnt vmcnt(10)
    s_barrier
    ds_read_b128 v[168:171], v8 offset:12288
    v_mul_f32 v132, v232, v132
    v_mfma_f32_16x16x32_bf16 v[128:131], v[176:179], v[64:67], v[128:131]
    v_mul_f32 v133, v232, v133
    v_mul_f32 v134, v232, v134
    v_mul_f32 v135, v232, v135
    v_mfma_f32_16x16x32_bf16 v[116:119], v[180:183], v[24:27], v[116:119]
    ds_read_b128 v[172:175], v12 offset:12288
    s_add_u32 m0, s53, 147072
    v_mfma_f32_16x16x32_bf16 v[132:135], v[180:183], v[64:67], v[132:135]
    s_waitcnt lgkmcnt(4)
    v_mfma_f32_16x16x32_bf16 v[248:251], v[184:187], v[184:187], v[248:251]
    ds_read_b128 v[176:179], v16 offset:12288
    buffer_load_dwordx4 v243, s[56:59], s52 offen offset:384 lds
    v_mfma_f32_16x16x32_bf16 v[252:255], v[184:187], v[244:247], v[252:255]
    v_mfma_f32_16x16x32_bf16 v[104:107], v[184:187], v[28:31], v[104:107]
    v_mfma_f32_16x16x32_bf16 v[120:123], v[184:187], v[68:71], v[120:123]
    v_mfma_f32_16x16x32_bf16 v[108:111], v[188:191], v[28:31], v[108:111]
    ds_read_b128 v[180:183], v20 offset:12288
    s_add_u32 m0, s53, 151104
    v_mfma_f32_16x16x32_bf16 v[124:127], v[188:191], v[68:71], v[124:127]
    s_waitcnt lgkmcnt(4)
    v_mfma_f32_16x16x32_bf16 v[112:115], v[192:195], v[28:31], v[112:115]
    ds_read_b128 v[184:187], v9 offset:12288
    buffer_load_dwordx4 v243, s[56:59], s52 offen offset:448 lds
    v_mfma_f32_16x16x32_bf16 v[128:131], v[192:195], v[68:71], v[128:131]
    s_mul_i32 s55, s55, 0x9e3779b1
    s_add_u32 s55, s55, 0x7f4a7c15
    v_mfma_f32_16x16x32_bf16 v[116:119], v[196:199], v[28:31], v[116:119]
    ds_read_b128 v[188:191], v13 offset:12288
    s_add_u32 s20, s6, 0x6e0000
    s_addc_u32 s21, s7, 0
    v_mfma_f32_16x16x32_bf16 v[132:135], v[196:199], v[68:71], v[132:135]
    s_mov_b32 s22, 0x18000
    s_waitcnt lgkmcnt(4)
    v_mfma_f32_16x16x32_bf16 v[248:251], v[168:171], v[168:171], v[248:251]
    ds_read_b128 v[192:195], v17 offset:12288
    s_add_u32 m0, s53, 155136
    s_mov_b32 s23, 0x20000
    v_mfma_f32_16x16x32_bf16 v[252:255], v[168:171], v[244:247], v[252:255]
    buffer_load_dwordx4 v243, s[56:59], s52 offen offset:512 lds
    v_mfma_f32_16x16x32_bf16 v[104:107], v[168:171], v[32:35], v[104:107]
    s_mov_b32 s43, 0xfffefffe
    v_and_b32 v238, 15, v2
    v_mfma_f32_16x16x32_bf16 v[120:123], v[168:171], v[72:75], v[120:123]
    v_lshlrev_b32 v238, 1, v238
    v_lshrrev_b32 v238, v238, s55
    v_mfma_f32_16x16x32_bf16 v[108:111], v[172:175], v[32:35], v[108:111]
    ds_read_b128 v[196:199], v21 offset:12288
    v_and_b32 v4, 1, v238
    v_bfe_u32 v238, v238, 1, 1
    v_mfma_f32_16x16x32_bf16 v[124:127], v[172:175], v[72:75], v[124:127]
    v_lshl_or_b32 v4, v238, 16, v4
    s_waitcnt lgkmcnt(4)
    v_mfma_f32_16x16x32_bf16 v[112:115], v[176:179], v[32:35], v[112:115]
    ds_read_b128 v[168:171], v10 offset:12288
    s_add_u32 m0, s53, 159168
    s_sub_u32 s24, s2, 8
    v_mfma_f32_16x16x32_bf16 v[128:131], v[176:179], v[72:75], v[128:131]
    buffer_load_dwordx4 v243, s[56:59], s52 offen offset:576 lds
    v_mfma_f32_16x16x32_bf16 v[116:119], v[180:183], v[32:35], v[116:119]
    ds_read_b128 v[172:175], v14 offset:12288
    s_lshr_b32 s25, s24, 3
    s_lshl_b32 s25, s25, 7
    v_mfma_f32_16x16x32_bf16 v[132:135], v[180:183], v[72:75], v[132:135]
    s_and_b32 s42, s24, 7
    s_waitcnt lgkmcnt(4)
    v_mfma_f32_16x16x32_bf16 v[248:251], v[184:187], v[184:187], v[248:251]
    ds_read_b128 v[176:179], v18 offset:12288
    s_lshl_b32 s42, s42, 2
    s_add_u32 s42, s42, s25
    v_mfma_f32_16x16x32_bf16 v[252:255], v[184:187], v[244:247], v[252:255]
    s_add_u32 m0, s53, 81280
    s_xor_b32 s25, s3, 3
    v_mfma_f32_16x16x32_bf16 v[104:107], v[184:187], v[36:39], v[104:107]
    buffer_load_dwordx4 v243, s[56:59], s52 offen offset:640 lds
    v_mfma_f32_16x16x32_bf16 v[120:123], v[184:187], v[76:79], v[120:123]
    s_lshl_b32 s25, s25, 8
    s_or_b32 s41, s25, s24
    v_mfma_f32_16x16x32_bf16 v[108:111], v[188:191], v[36:39], v[108:111]
    ds_read_b128 v[180:183], v22 offset:12288
    v_and_b32 v5, 7, v0
    v_lshlrev_b32 v5, 11, v5
    v_mfma_f32_16x16x32_bf16 v[124:127], v[188:191], v[76:79], v[124:127]
    v_mov_b32 v6, s55
    s_waitcnt lgkmcnt(4)
    v_mfma_f32_16x16x32_bf16 v[112:115], v[192:195], v[36:39], v[112:115]
    ds_read_b128 v[184:187], v11 offset:12288
    s_add_u32 m0, s53, 85312
    s_and_b32 s79, s2, 7
    v_mfma_f32_16x16x32_bf16 v[128:131], v[192:195], v[76:79], v[128:131]
    buffer_load_dwordx4 v243, s[56:59], s52 offen offset:704 lds
    v_mfma_f32_16x16x32_bf16 v[116:119], v[196:199], v[36:39], v[116:119]
    ds_read_b128 v[188:191], v15 offset:12288
    s_lshl_b32 s79, s79, 11
    s_cmp_eq_u32 s49, 7
    s_cselect_b32 s24, 5, 7
    v_mfma_f32_16x16x32_bf16 v[132:135], v[196:199], v[76:79], v[132:135]
    s_and_b32 s25, s2, 7
    s_waitcnt lgkmcnt(4)
    v_mfma_f32_16x16x32_bf16 v[248:251], v[168:171], v[168:171], v[248:251]
    ds_read_b128 v[192:195], v19 offset:12288
    s_add_u32 m0, s53, 89344
    s_lshl_b32 s25, s25, 3
    v_mfma_f32_16x16x32_bf16 v[252:255], v[168:171], v[244:247], v[252:255]
    buffer_load_dwordx4 v243, s[56:59], s52 offen offset:768 lds
    v_mfma_f32_16x16x32_bf16 v[104:107], v[168:171], v[40:43], v[104:107]
    s_add_u32 s25, s25, s49
    s_add_u32 s25, s25, 32
    v_mfma_f32_16x16x32_bf16 v[120:123], v[168:171], v[80:83], v[120:123]
    s_lshl_b32 s25, s25, 10
    v_min_u32 v7, s24, v0
    v_mfma_f32_16x16x32_bf16 v[108:111], v[172:175], v[40:43], v[108:111]
    ds_read_b128 v[196:199], v23 offset:12288
    v_lshl_add_u32 v7, v7, 2, s25
    v_mfma_f32_16x16x32_bf16 v[124:127], v[172:175], v[80:83], v[124:127]
    s_waitcnt lgkmcnt(4)
    v_mfma_f32_16x16x32_bf16 v[112:115], v[176:179], v[40:43], v[112:115]
    s_waitcnt vmcnt(13)
    s_barrier
    ds_read_b128 v[168:171], v8 offset:16384
    v_mfma_f32_16x16x32_bf16 v[128:131], v[176:179], v[80:83], v[128:131]
    s_add_u32 m0, s53, 93376
    v_mfma_f32_16x16x32_bf16 v[116:119], v[180:183], v[40:43], v[116:119]
    ds_read_b128 v[172:175], v9 offset:16384
    buffer_load_dwordx4 v243, s[56:59], s52 offen offset:832 lds
    v_mfma_f32_16x16x32_bf16 v[132:135], v[180:183], v[80:83], v[132:135]
    s_waitcnt lgkmcnt(4)
    v_mfma_f32_16x16x32_bf16 v[248:251], v[184:187], v[184:187], v[248:251]
    ds_read_b128 v[176:179], v10 offset:16384
    v_mfma_f32_16x16x32_bf16 v[252:255], v[184:187], v[244:247], v[252:255]
    v_mfma_f32_16x16x32_bf16 v[104:107], v[184:187], v[44:47], v[104:107]
    s_add_u32 m0, s53, 97408
    v_mfma_f32_16x16x32_bf16 v[120:123], v[184:187], v[84:87], v[120:123]
    buffer_load_dwordx4 v243, s[56:59], s52 offen offset:896 lds
    v_mfma_f32_16x16x32_bf16 v[108:111], v[188:191], v[44:47], v[108:111]
    ds_read_b128 v[180:183], v11 offset:16384
    v_mfma_f32_16x16x32_bf16 v[124:127], v[188:191], v[84:87], v[124:127]
    s_waitcnt lgkmcnt(4)
    v_mfma_f32_16x16x32_bf16 v[112:115], v[192:195], v[44:47], v[112:115]
    ds_read_b128 v[184:187], v16 offset:16384
    v_mfma_f32_16x16x32_bf16 v[128:131], v[192:195], v[84:87], v[128:131]
    s_add_u32 m0, s53, 101440
    v_mfma_f32_16x16x32_bf16 v[116:119], v[196:199], v[44:47], v[116:119]
    ds_read_b128 v[188:191], v17 offset:16384
    buffer_load_dwordx4 v243, s[56:59], s52 offen offset:960 lds
    v_mfma_f32_16x16x32_bf16 v[132:135], v[196:199], v[84:87], v[132:135]
    s_waitcnt lgkmcnt(4)
    v_mfma_f32_16x16x32_bf16 v[248:251], v[168:171], v[168:171], v[248:251]
    ds_read_b128 v[192:195], v18 offset:16384
    v_mfma_f32_16x16x32_bf16 v[252:255], v[168:171], v[244:247], v[252:255]
    v_mfma_f32_16x16x32_bf16 v[104:107], v[168:171], v[48:51], v[104:107]
    s_add_u32 m0, s53, 105472
    v_mfma_f32_16x16x32_bf16 v[120:123], v[168:171], v[88:91], v[120:123]
    buffer_load_dwordx4 v243, s[56:59], s52 offen offset:1024 lds
    v_mfma_f32_16x16x32_bf16 v[248:251], v[172:175], v[172:175], v[248:251]
    ds_read_b128 v[196:199], v19 offset:16384
    v_mfma_f32_16x16x32_bf16 v[252:255], v[172:175], v[244:247], v[252:255]
    v_mfma_f32_16x16x32_bf16 v[104:107], v[172:175], v[52:55], v[104:107]
    v_mfma_f32_16x16x32_bf16 v[120:123], v[172:175], v[92:95], v[120:123]
    s_waitcnt lgkmcnt(4)
    v_mfma_f32_16x16x32_bf16 v[248:251], v[176:179], v[176:179], v[248:251]
    ds_read_b128 v[168:171], v12 offset:16384
    s_add_u32 m0, s53, 109504
    v_mfma_f32_16x16x32_bf16 v[252:255], v[176:179], v[244:247], v[252:255]
    buffer_load_dwordx4 v243, s[56:59], s52 offen offset:1088 lds
    v_mfma_f32_16x16x32_bf16 v[104:107], v[176:179], v[56:59], v[104:107]
    v_mfma_f32_16x16x32_bf16 v[120:123], v[176:179], v[96:99], v[120:123]
    v_mfma_f32_16x16x32_bf16 v[248:251], v[180:183], v[180:183], v[248:251]
    ds_read_b128 v[172:175], v13 offset:16384
    v_mfma_f32_16x16x32_bf16 v[252:255], v[180:183], v[244:247], v[252:255]
    s_add_u32 m0, s53, 113536
    v_mfma_f32_16x16x32_bf16 v[104:107], v[180:183], v[60:63], v[104:107]
    buffer_load_dwordx4 v243, s[56:59], s52 offen offset:1152 lds
    v_mfma_f32_16x16x32_bf16 v[120:123], v[180:183], v[100:103], v[120:123]
    s_waitcnt lgkmcnt(4)
    v_mfma_f32_16x16x32_bf16 v[112:115], v[184:187], v[48:51], v[112:115]
    ds_read_b128 v[176:179], v14 offset:16384
    v_mfma_f32_16x16x32_bf16 v[128:131], v[184:187], v[88:91], v[128:131]
    v_mfma_f32_16x16x32_bf16 v[112:115], v[188:191], v[52:55], v[112:115]
    ds_read_b128 v[180:183], v15 offset:16384
    v_cndmask_b32 v238, v252, v253, s[36:37]
    v_cndmask_b32 v240, v254, v255, s[36:37]
    v_cndmask_b32 v238, v238, v240, s[38:39]
    v_mfma_f32_16x16x32_bf16 v[128:131], v[188:191], v[92:95], v[128:131]
    s_add_u32 m0, s53, 117568
    v_cndmask_b32 v239, v248, v249, s[36:37]
    s_waitcnt lgkmcnt(4)
    v_mfma_f32_16x16x32_bf16 v[112:115], v[192:195], v[56:59], v[112:115]
    ds_read_b128 v[184:187], v20 offset:16384
    v_cndmask_b32 v240, v250, v251, s[36:37]
    v_cndmask_b32 v239, v239, v240, s[38:39]
    v_mul_f32 v238, 0x3acccccd, v238
    v_mfma_f32_16x16x32_bf16 v[128:131], v[192:195], v[96:99], v[128:131]
    v_mul_f32 v239, 0x3acccccd, v239
    v_fma_f32 v239, -v238, v238, v239
    v_max_f32 v239, 0, v239
    v_mfma_f32_16x16x32_bf16 v[112:115], v[196:199], v[60:63], v[112:115]
    ds_read_b128 v[188:191], v21 offset:16384
    v_cvt_pk_bf16_f32 v239, v239, v239
    v_and_b32 v239, 0xffff0000, v239
    v_add_f32 v239, 0x3727c5ac, v239
    v_mfma_f32_16x16x32_bf16 v[128:131], v[196:199], v[100:103], v[128:131]
    buffer_load_dwordx4 v243, s[56:59], s52 offen offset:1216 lds
    s_waitcnt lgkmcnt(4)
    v_mfma_f32_16x16x32_bf16 v[108:111], v[168:171], v[48:51], v[108:111]
    ds_read_b128 v[192:195], v22 offset:16384
    v_cvt_pk_bf16_f32 v239, v239, v239
    v_and_b32 v239, 0xffff0000, v239
    v_sqrt_f32 v239, v239
    v_mfma_f32_16x16x32_bf16 v[124:127], v[168:171], v[88:91], v[124:127]
    v_cvt_pk_bf16_f32 v239, v239, v239
    v_and_b32 v239, 0xffff0000, v239
    v_rcp_f32 v239, v239
    v_mfma_f32_16x16x32_bf16 v[108:111], v[172:175], v[52:55], v[108:111]
    ds_read_b128 v[196:199], v23 offset:16384
    ds_write_b32 v233, v239
    s_waitcnt lgkmcnt(0)
    s_barrier
    ds_read_b128 v[24:27], v234
    ds_read_b128 v[32:35], v236
    ds_read_b128 v[28:31], v235
    ds_read_b128 v[36:39], v237
    v_mfma_f32_16x16x32_bf16 v[124:127], v[172:175], v[92:95], v[124:127]
    v_mfma_f32_16x16x32_bf16 v[108:111], v[176:179], v[56:59], v[108:111]
    s_cmp_ge_u32 s41, 32
    s_cbranch_scc1 L1_nohint
    buffer_store_dword v6, v5, s[20:23], s42 offen offset:512 sc1
L1_nohint:
    v_mov_b32 v238, v7
    v_mfma_f32_16x16x32_bf16 v[124:127], v[176:179], v[96:99], v[124:127]
    buffer_load_dword v239, v238, s[20:23], 0 offen sc1
    v_mfma_f32_16x16x32_bf16 v[108:111], v[180:183], v[60:63], v[108:111]
    s_waitcnt lgkmcnt(2)
    v_mul_f32 v40, v24, v104
    v_mul_f32 v41, v25, v105
    v_mfma_f32_16x16x32_bf16 v[124:127], v[180:183], v[100:103], v[124:127]
    v_mul_f32 v42, v26, v106
    v_mul_f32 v43, v27, v107
    v_mfma_f32_16x16x32_bf16 v[116:119], v[184:187], v[48:51], v[116:119]
    v_fma_f32 v104, v32, v112, v40
    v_fma_f32 v112, -v32, v112, v40
    v_fma_f32 v105, v33, v113, v41
    v_mfma_f32_16x16x32_bf16 v[132:135], v[184:187], v[88:91], v[132:135]
    v_fma_f32 v113, -v33, v113, v41
    v_fma_f32 v106, v34, v114, v42
    v_fma_f32 v114, -v34, v114, v42
    v_mfma_f32_16x16x32_bf16 v[116:119], v[188:191], v[52:55], v[116:119]
    v_fma_f32 v107, v35, v115, v43
    v_fma_f32 v115, -v35, v115, v43
    v_cvt_pk_bf16_f32 v64, v104, v105
    v_mfma_f32_16x16x32_bf16 v[132:135], v[188:191], v[92:95], v[132:135]
    v_cvt_pk_bf16_f32 v65, v106, v107
    v_cvt_pk_bf16_f32 v72, v112, v113
    v_mfma_f32_16x16x32_bf16 v[116:119], v[192:195], v[56:59], v[116:119]
    v_cvt_pk_bf16_f32 v73, v114, v115
    v_mul_f32 v40, v24, v120
    v_mul_f32 v41, v25, v121
    v_mfma_f32_16x16x32_bf16 v[132:135], v[192:195], v[96:99], v[132:135]
    v_mul_f32 v42, v26, v122
    v_mul_f32 v43, v27, v123
    v_fma_f32 v120, v32, v128, v40
    v_mfma_f32_16x16x32_bf16 v[116:119], v[196:199], v[60:63], v[116:119]
    v_fma_f32 v128, -v32, v128, v40
    v_fma_f32 v121, v33, v129, v41
    v_fma_f32 v129, -v33, v129, v41
    v_mfma_f32_16x16x32_bf16 v[132:135], v[196:199], v[100:103], v[132:135]
    v_fma_f32 v122, v34, v130, v42
    v_fma_f32 v130, -v34, v130, v42
    v_fma_f32 v123, v35, v131, v43
    v_fma_f32 v131, -v35, v131, v43
    v_cvt_pk_bf16_f32 v68, v120, v121
    v_cvt_pk_bf16_f32 v69, v122, v123
    v_cvt_pk_bf16_f32 v76, v128, v129
    v_cvt_pk_bf16_f32 v77, v130, v131
    s_waitcnt lgkmcnt(0)
    v_pk_mul_f32 v[40:41], v[28:29], v[108:109]
    v_pk_mul_f32 v[42:43], v[30:31], v[110:111]
    v_pk_fma_f32 v[108:109], v[36:37], v[116:117], v[40:41]
    v_pk_fma_f32 v[110:111], v[38:39], v[118:119], v[42:43]
    v_pk_fma_f32 v[116:117], v[36:37], v[116:117], v[40:41] neg_lo:[1,0,0] neg_hi:[1,0,0]
    v_pk_fma_f32 v[118:119], v[38:39], v[118:119], v[42:43] neg_lo:[1,0,0] neg_hi:[1,0,0]
    v_cvt_pk_bf16_f32 v66, v108, v109
    v_cvt_pk_bf16_f32 v67, v110, v111
    v_cvt_pk_bf16_f32 v74, v116, v117
    v_cvt_pk_bf16_f32 v75, v118, v119
    v_pk_mul_f32 v[40:41], v[28:29], v[124:125]
    v_pk_mul_f32 v[42:43], v[30:31], v[126:127]
    v_pk_fma_f32 v[124:125], v[36:37], v[132:133], v[40:41]
    v_pk_fma_f32 v[126:127], v[38:39], v[134:135], v[42:43]
    v_pk_fma_f32 v[132:133], v[36:37], v[132:133], v[40:41] neg_lo:[1,0,0] neg_hi:[1,0,0]
    v_pk_fma_f32 v[134:135], v[38:39], v[134:135], v[42:43] neg_lo:[1,0,0] neg_hi:[1,0,0]
    v_cvt_pk_bf16_f32 v70, v124, v125
    v_cvt_pk_bf16_f32 v71, v126, v127
    v_cvt_pk_bf16_f32 v78, v132, v133
    v_cvt_pk_bf16_f32 v79, v134, v135
    v_mfma_f32_16x16x32_bf16 v[168:171], v[200:203], v[64:67], 0
    v_mfma_f32_16x16x32_bf16 v[172:175], v[200:203], v[68:71], 0
    v_mfma_f32_16x16x32_bf16 v[168:171], v[204:207], v[68:71], v[168:171]
    v_mfma_f32_16x16x32_bf16 v[172:175], v[152:155], v[64:67], v[172:175]
    v_mfma_f32_16x16x32_bf16 v[176:179], v[208:211], v[64:67], 0
    v_mfma_f32_16x16x32_bf16 v[180:183], v[208:211], v[68:71], 0
    v_mfma_f32_16x16x32_bf16 v[176:179], v[212:215], v[68:71], v[176:179]
    s_nop 4
    v_cvt_pk_f16_f32 v104, v168, v172
    v_cvt_pk_f16_f32 v105, v169, v173
    v_cvt_pk_f16_f32 v106, v170, v174
    v_mfma_f32_16x16x32_bf16 v[180:183], v[156:159], v[64:67], v[180:183]
    v_cvt_pk_f16_f32 v107, v171, v175
    v_and_or_b32 v104, v104, s43, v4
    global_store_dword v136, v104, s[6:7] sc1
    v_mfma_f32_16x16x32_bf16 v[184:187], v[216:219], v[72:75], 0
    v_and_or_b32 v105, v105, s43, v4
    global_store_dword v137, v105, s[6:7] sc1
    v_and_or_b32 v106, v106, s43, v4
    v_mfma_f32_16x16x32_bf16 v[188:191], v[216:219], v[76:79], 0
    global_store_dword v138, v106, s[6:7] sc1
    v_and_or_b32 v107, v107, s43, v4
    global_store_dword v139, v107, s[6:7] sc1
    v_mfma_f32_16x16x32_bf16 v[184:187], v[220:223], v[76:79], v[184:187]
    v_cvt_pk_f16_f32 v108, v176, v180
    v_cvt_pk_f16_f32 v109, v177, v181
    v_cvt_pk_f16_f32 v110, v178, v182
    v_mfma_f32_16x16x32_bf16 v[188:191], v[160:163], v[72:75], v[188:191]
    v_cvt_pk_f16_f32 v111, v179, v183
    v_and_or_b32 v108, v108, s43, v4
    global_store_dword v140, v108, s[6:7] sc1
    v_mfma_f32_16x16x32_bf16 v[192:195], v[224:227], v[72:75], 0
    v_and_or_b32 v109, v109, s43, v4
    global_store_dword v141, v109, s[6:7] sc1
    v_and_or_b32 v110, v110, s43, v4
    v_mfma_f32_16x16x32_bf16 v[196:199], v[224:227], v[76:79], 0
    global_store_dword v142, v110, s[6:7] sc1
    v_and_or_b32 v111, v111, s43, v4
    global_store_dword v143, v111, s[6:7] sc1
    v_mfma_f32_16x16x32_bf16 v[192:195], v[228:231], v[76:79], v[192:195]
    v_cvt_pk_f16_f32 v112, v184, v188
    v_cvt_pk_f16_f32 v113, v185, v189
    v_cvt_pk_f16_f32 v114, v186, v190
    v_mfma_f32_16x16x32_bf16 v[196:199], v[164:167], v[72:75], v[196:199]
    v_cvt_pk_f16_f32 v115, v187, v191
    v_and_or_b32 v112, v112, s43, v4
    global_store_dword v144, v112, s[6:7] sc1
    v_and_or_b32 v113, v113, s43, v4
    global_store_dword v145, v113, s[6:7] sc1
    v_and_or_b32 v114, v114, s43, v4
    global_store_dword v146, v114, s[6:7] sc1
    v_and_or_b32 v115, v115, s43, v4
    global_store_dword v147, v115, s[6:7] sc1
    v_cvt_pk_f16_f32 v116, v192, v196
    v_cvt_pk_f16_f32 v117, v193, v197
    v_cvt_pk_f16_f32 v118, v194, v198
    v_cvt_pk_f16_f32 v119, v195, v199
    v_and_or_b32 v116, v116, s43, v4
    global_store_dword v148, v116, s[6:7] sc1
    v_and_or_b32 v117, v117, s43, v4
    global_store_dword v149, v117, s[6:7] sc1
    v_and_or_b32 v118, v118, s43, v4
    global_store_dword v150, v118, s[6:7] sc1
    v_and_or_b32 v119, v119, s43, v4
    global_store_dword v151, v119, s[6:7] sc1
    s_waitcnt vmcnt(16)
L_join:
    s_nop 1
    v_lshlrev_b32 v3, 4, v0
    s_barrier
    s_mov_b32 s45, 0
L_gcW:
    v_cmp_ne_u32 vcc, s55, v239
    s_nop 1
    s_or_b32 s47, vcc_lo, vcc_hi
    s_cbranch_scc0 L_ggW
    s_add_u32 s45, s45, 1
    s_cmp_ge_u32 s45, 0x40000
    s_cbranch_scc1 L_ggW
    s_sleep 4
    buffer_load_dword v239, v238, s[20:23], 0 offen sc1
    s_waitcnt vmcnt(0)
    s_branch L_gcW
L_ggW:
    s_mul_i32 s24, s49, 301056
    s_mul_i32 s25, s51, 10240
    s_add_u32 s24, s24, s25
    s_mul_i32 s26, s3, 21504
    s_add_u32 s10, s24, s26
    s_add_u32 s8, s10, s26
    s_add_u32 s9, s8, 21504
    s_add_u32 s10, s10, 172032
    s_lshr_b32 s26, s3, 1
    s_mul_i32 s26, s26, 21504
    s_add_u32 s11, s24, s26
    s_add_u32 s11, s11, 258048
    s_cmp_ge_u32 s10, 2322432
    s_cselect_b32 s26, 86016, 0
    s_sub_u32 s10, s10, s26
    s_cmp_ge_u32 s11, 2322432
    s_cselect_b32 s26, 86016, 0
    s_sub_u32 s11, s11, s26
    s_sub_u32 s72, 20480, s25
    s_lshl_b32 s25, s25, 1
    s_sub_u32 s25, 10240, s25
    s_add_u32 s68, s8, s25
    s_add_u32 s69, s9, s25
    s_add_u32 s70, s10, s25
    s_add_u32 s36, s6, 0x280000
    s_addc_u32 s37, s7, 0
    s_mov_b32 s38, 0x237000
    s_mov_b32 s39, 0x20000
    v_lshlrev_b32 v155, 4, v0
    v_min_u32 v155, 152, v155
    v_bfe_u32 v151, v0, 3, 3
    v_min_u32 v151, 3, v151
    v_and_b32 v154, 7, v0
    v_lshlrev_b32 v154, 2, v154
    v_lshl_add_u32 v154, v151, 7, v154
    s_bitcmp1_b32 s54, 0
    s_cbranch_scc1 L_joinN
    s_add_u32 s12, s8, 0
    buffer_load_dwordx4 a[0:3], v3, s[36:39], s12 offen offset:0 sc1
    s_add_u32 s13, s9, 0
    buffer_load_dwordx4 a[4:7], v3, s[36:39], s13 offen offset:0 sc1
    s_add_u32 s18, s10, 0
    buffer_load_dwordx4 a[8:11], v3, s[36:39], s18 offen offset:0 sc1
    s_add_u32 s19, s11, 0
    buffer_load_dwordx4 a[12:15], v3, s[36:39], s19 offen offset:0 sc1
    v_lshrrev_b32 v1, 5, v0
    buffer_load_dwordx4 a[16:19], v3, s[36:39], s12 offen offset:1024 sc1
    v_and_b32 v2, 31, v0
    v_and_b32 v207, 3, v0
    v_bfe_u32 v193, v0, 2, 1
    v_lshl_add_u32 v207, v193, 4, v207
    v_bfe_u32 v193, v0, 3, 2
    v_lshl_add_u32 v207, v193, 2, v207
    v_mul_u32_u24 v10, 5120, v1
    v_lshl_add_u32 v10, v207, 2, v10
    s_mul_i32 s45, s50, 40960
    s_mul_i32 s44, s51, 640
    s_add_u32 s45, s45, s44
    s_add_u32 s45, s45, 2048
    v_add_u32 v10, s45, v10
    buffer_load_dwordx4 a[20:23], v3, s[36:39], s13 offen offset:1024 sc1
    v_add_u32 v11, 10240, v10
    v_add_u32 v12, 20480, v10
    v_add_u32 v13, 30720, v10
    s_mov_b32 s28, s14
    s_mov_b32 s29, s15
    s_mov_b32 s30, 0x500
    s_mov_b32 s31, 0x20000
    s_mov_b32 s32, s16
    s_mov_b32 s33, s17
    s_mov_b32 s34, 0x280000
    s_mov_b32 s35, 0x20000
    s_mul_i32 s24, s48, 276480
    s_add_u32 s24, s24, 0x700000
    s_add_u32 s64, s6, s24
    s_addc_u32 s65, s7, 0
    s_mov_b32 s66, 276480
    s_mov_b32 s67, 0x20000
    s_mul_i32 s24, s49, 276480
    s_add_u32 s24, s24, 0x4c0000
    s_add_u32 s60, s6, s24
    s_addc_u32 s61, s7, 0
    s_mov_b32 s62, 276480
    s_mov_b32 s63, 0x20000
    s_mul_i32 s27, s49, 160
    s_mul_i32 s78, s48, 1280
    s_add_u32 s78, s78, s27
    s_sub_u32 s24, 64, s48
    s_cmp_eq_u32 s48, 0
    s_cselect_b32 s24, 32, s24
    s_mul_i32 s14, s24, 1280
    s_add_u32 s14, s14, s27
    v_lshlrev_b32 v197, 2, v0
    buffer_load_dwordx4 a[24:27], v3, s[36:39], s18 offen offset:1024 sc1
    buffer_load_dword v131, v197, s[28:31], s27 offen
    s_mul_i32 s76, s3, 5120
    s_mul_i32 s42, s49, 35840
    s_add_u32 s40, s42, s76
    s_lshr_b32 s41, s3, 1
    s_mul_i32 s41, s41, 5120
    s_add_u32 s41, s41, s42
    s_add_u32 s41, s41, 20480
    s_add_u32 s42, s42, 30720
    s_add_u32 s77, s49, 1
    s_and_b32 s77, s77, 7
    s_mul_i32 s77, s77, 35840
    s_add_u32 s4, s77, s76
    s_add_u32 s77, s49, 2
    s_and_b32 s77, s77, 7
    s_mul_i32 s77, s77, 35840
    s_add_u32 s5, s77, s76
    s_add_u32 s77, s49, 3
    s_and_b32 s77, s77, 7
    s_mul_i32 s77, s77, 35840
    s_add_u32 s15, s77, s76
    s_add_u32 s77, s49, 4
    s_and_b32 s77, s77, 7
    s_mul_i32 s77, s77, 35840
    s_add_u32 s16, s77, s76
    s_add_u32 s77, s49, 5
    s_and_b32 s77, s77, 7
    s_mul_i32 s77, s77, 35840
    s_add_u32 s17, s77, s76
    s_add_u32 s77, s49, 6
    s_and_b32 s77, s77, 7
    s_mul_i32 s77, s77, 35840
    s_add_u32 s43, s77, s76
    s_add_u32 s77, s49, 7
    s_and_b32 s77, s77, 7
    s_mul_i32 s77, s77, 35840
    s_add_u32 s56, s77, s76
    s_mul_i32 s76, s3, 71680
    s_add_u32 s57, s76, 20480
    s_add_u32 s58, s76, 56320
    s_add_u32 s59, s76, 25600
    s_add_u32 s73, s76, 30720
    s_add_u32 s74, s76, 61440
    s_add_u32 s75, s76, 66560
    v_cvt_f32_u32 v192, v2
    buffer_load_dwordx4 a[28:31], v3, s[36:39], s19 offen offset:1024 sc1
    v_mul_f32 v192, 0x3d000000, v192
    v_cvt_f32_u32 v193, v1
    v_mul_f32 v193, 4.0, v193
    v_add_f32 v194, 0x00000000, v193
    v_mul_f32 v194, v194, v192
    v_add_f32 v195, v194, v192
    v_cos_f32 v196, v194
    buffer_load_dwordx4 a[32:35], v3, s[36:39], s12 offen offset:2048 sc1
    v_sin_f32 v197, v194
    v_cos_f32 v198, v195
    v_sin_f32 v199, v195
    v_cvt_pk_f16_f32 v160, v196, v197
    v_cvt_pk_f16_f32 v161, v198, v199
    v_add_f32 v194, 0x40000000, v193
    v_mul_f32 v194, v194, v192
    v_add_f32 v195, v194, v192
    v_cos_f32 v196, v194
    v_sin_f32 v197, v194
    buffer_load_dwordx4 a[36:39], v3, s[36:39], s13 offen offset:2048 sc1
    v_cos_f32 v198, v195
    v_sin_f32 v199, v195
    buffer_load_dword v151, v154, s[20:23], s79 offen offset:512 sc1
    v_cvt_pk_f16_f32 v162, v196, v197
    v_cvt_pk_f16_f32 v163, v198, v199
    v_add_f32 v194, 0x41000000, v193
    v_mul_f32 v194, v194, v192
    v_add_f32 v195, v194, v192
    v_cos_f32 v196, v194
    buffer_load_dwordx4 a[40:43], v3, s[36:39], s18 offen offset:2048 sc1
    v_sin_f32 v197, v194
    v_cos_f32 v198, v195
    v_sin_f32 v199, v195
    v_cvt_pk_f16_f32 v164, v196, v197
    v_cvt_pk_f16_f32 v165, v198, v199
    v_add_f32 v194, 0x41200000, v193
    v_mul_f32 v194, v194, v192
    v_add_f32 v195, v194, v192
    v_cos_f32 v196, v194
    buffer_load_dwordx4 a[44:47], v3, s[36:39], s19 offen offset:2048 sc1
    v_sin_f32 v197, v194
    v_cos_f32 v198, v195
    v_sin_f32 v199, v195
    v_cvt_pk_f16_f32 v166, v196, v197
    v_cvt_pk_f16_f32 v167, v198, v199
    v_add_f32 v194, 0x41800000, v193
    v_mul_f32 v194, v194, v192
    v_add_f32 v195, v194, v192
    v_cos_f32 v196, v194
    v_sin_f32 v197, v194
    buffer_load_dwordx4 a[48:51], v3, s[36:39], s12 offen offset:3072 sc1
    v_cos_f32 v198, v195
    v_sin_f32 v199, v195
    v_cvt_pk_f16_f32 v168, v196, v197
    v_cvt_pk_f16_f32 v169, v198, v199
    v_add_f32 v194, 0x41900000, v193
    v_mul_f32 v194, v194, v192
    v_add_f32 v195, v194, v192
    v_cos_f32 v196, v194
    v_sin_f32 v197, v194
    buffer_load_dwordx4 a[52:55], v3, s[36:39], s13 offen offset:3072 sc1
    v_cos_f32 v198, v195
    v_sin_f32 v199, v195
    v_cvt_pk_f16_f32 v170, v196, v197
    v_cvt_pk_f16_f32 v171, v198, v199
    v_add_f32 v194, 0x41c00000, v193
    v_mul_f32 v194, v194, v192
    v_add_f32 v195, v194, v192
    v_cos_f32 v196, v194
    v_sin_f32 v197, v194
    v_cos_f32 v198, v195
    buffer_load_dwordx4 a[56:59], v3, s[36:39], s18 offen offset:3072 sc1
    v_sin_f32 v199, v195
    v_cvt_pk_f16_f32 v172, v196, v197
    v_cvt_pk_f16_f32 v173, v198, v199
    v_add_f32 v194, 0x41d00000, v193
    v_mul_f32 v194, v194, v192
    v_add_f32 v195, v194, v192
    v_cos_f32 v196, v194
    v_sin_f32 v197, v194
    v_cos_f32 v198, v195
    buffer_load_dwordx4 a[60:63], v3, s[36:39], s19 offen offset:3072 sc1
    v_sin_f32 v199, v195
    v_cvt_pk_f16_f32 v174, v196, v197
    v_cvt_pk_f16_f32 v175, v198, v199
    v_lshlrev_b32 v195, 2, v1
    v_and_b32 v192, 1, v207
    v_lshlrev_b32 v192, 4, v192
    v_mov_b32 v193, 0x3f80
    v_lshlrev_b32 v192, v192, v193
    v_lshrrev_b32 v193, 1, v207
    v_sub_u32 v193, v193, v195
    v_cmp_eq_u32 s[46:47], 0, v193
    v_cmp_eq_u32 vcc, 1, v193
    s_add_u32 s12, s8, 4096
    buffer_load_dwordx4 a[64:67], v3, s[36:39], s12 offen offset:0 sc1
    v_cndmask_b32 v176, 0, v192, s[46:47]
    v_cndmask_b32 v177, 0, v192, vcc
    v_cmp_eq_u32 s[46:47], 2, v193
    v_cmp_eq_u32 vcc, 3, v193
    s_nop 0
    v_cndmask_b32 v178, 0, v192, s[46:47]
    v_cndmask_b32 v179, 0, v192, vcc
    v_cmp_eq_u32 s[46:47], 8, v193
    v_cmp_eq_u32 vcc, 9, v193
    s_nop 0
    v_cndmask_b32 v180, 0, v192, s[46:47]
    v_cndmask_b32 v181, 0, v192, vcc
    s_add_u32 s13, s9, 4096
    buffer_load_dwordx4 a[68:71], v3, s[36:39], s13 offen offset:0 sc1
    v_cmp_eq_u32 s[46:47], 10, v193
    v_cmp_eq_u32 vcc, 11, v193
    s_nop 0
    v_cndmask_b32 v182, 0, v192, s[46:47]
    v_cndmask_b32 v183, 0, v192, vcc
    v_sub_u32 v196, 32, v207
    v_and_b32 v192, 1, v196
    v_lshlrev_b32 v192, 4, v192
    v_mov_b32 v193, 0x3f80
    v_lshlrev_b32 v192, v192, v193
    v_lshrrev_b32 v193, 1, v196
    v_sub_u32 v193, v193, v195
    v_cmp_eq_u32 s[46:47], 0, v193
    v_cmp_eq_u32 vcc, 1, v193
    s_nop 0
    v_cndmask_b32 v184, 0, v192, s[46:47]
    v_cndmask_b32 v185, 0, v192, vcc
    v_cmp_eq_u32 s[46:47], 2, v193
    v_cmp_eq_u32 vcc, 3, v193
    s_nop 0
    v_cndmask_b32 v186, 0, v192, s[46:47]
    v_cndmask_b32 v187, 0, v192, vcc
    v_cmp_eq_u32 s[46:47], 8, v193
    v_cmp_eq_u32 vcc, 9, v193
    s_nop 0
    v_cndmask_b32 v188, 0, v192, s[46:47]
    v_cndmask_b32 v189, 0, v192, vcc
    v_cmp_eq_u32 s[46:47], 10, v193
    v_cmp_eq_u32 vcc, 11, v193
    s_nop 0
    v_cndmask_b32 v190, 0, v192, s[46:47]
    v_cndmask_b32 v191, 0, v192, vcc
    v_add_u32 v4, 4096, v3
    s_lshr_b32 s45, s3, 1
    s_lshl_b32 s45, s45, 5
    v_add_u32 v192, s45, v2
    v_lshlrev_b32 v193, 6, v2
    v_add_u32 v193, s50, v193
    v_sub_u32 v193, 2048, v193
    v_and_b32 v194, 63, v193
    v_bfe_u32 v193, v193, 6, 5
    v_cmp_ne_u32 s[46:47], s48, v194
    s_nop 1
    v_cndmask_b32 v194, 0, 32, s[46:47]
    v_add_u32 v193, v193, v194
    v_lshrrev_b32 v194, 1, v192
    v_and_b32 v194, 6, v194
    s_movk_i32 s44, 0x78
    v_bfe_u32 v194, s44, v194, 2
    v_lshlrev_b32 v194, 4, v194
    v_lshl_add_u32 v194, v192, 6, v194
    s_mul_i32 s44, s51, 20480
    s_add_u32 s45, s44, 122880
    v_add_u32 v194, s45, v194
    v_lshrrev_b32 v196, 1, v193
    v_and_b32 v196, 6, v196
    s_movk_i32 s44, 0x78
    v_bfe_u32 v196, s44, v196, 2
    v_lshlrev_b32 v196, 4, v196
    v_lshl_add_u32 v196, v193, 6, v196
    s_mul_i32 s44, s51, 20480
    s_sub_u32 s44, 61440, s44
    v_add_u32 v196, s44, v196
    v_lshlrev_b32 v197, 4, v1
    v_lshlrev_b32 v198, 5, v1
    v_xor_b32 v14, v194, v198
    v_xor_b32 v15, 16, v14
    v_xor_b32 v16, v196, v198
    v_xor_b32 v16, 32, v16
    v_xor_b32 v17, 16, v16
    v_xor_b32 v18, v194, v197
    v_xor_b32 v19, 32, v18
    v_xor_b32 v20, v196, v197
    v_xor_b32 v21, 32, v20
    v_add_u32 v22, 4096, v196
    s_cmp_eq_u32 s51, 0
    s_cselect_b32 s44, 40960, 0
    v_subrev_u32 v23, s44, v22
    v_or_b32 v197, s51, v1
    v_cmp_eq_u32 s[46:47], 0, v197
    s_nop 1
    v_cndmask_b32 v24, 0, -1.0, s[46:47]
    v_cvt_f32_u32 v25, v1
    v_sub_f32 v25, 1.0, v25
    v_lshrrev_b32 v194, 1, v0
    v_and_b32 v194, 6, v194
    s_movk_i32 s44, 0x78
    v_bfe_u32 v194, s44, v194, 2
    v_lshrrev_b32 v195, 4, v0
    v_xor_b32 v194, v194, v195
    v_lshlrev_b32 v194, 4, v194
    v_and_b32 v195, 15, v0
    v_lshl_add_u32 v194, v195, 6, v194
    s_mul_i32 s44, s51, -80896
    s_add_u32 s44, s44, 122880
    v_add_u32 v5, s44, v194
    v_xor_b32 v6, 1024, v5
    s_mul_i32 s44, s51, 82944
    s_add_u32 s44, s44, 40960
    v_add_u32 v7, s44, v194
    v_xor_b32 v8, 1024, v7
    v_mov_b32 v128, 0
    v_mov_b32 v148, 0
    v_mov_b32 v26, 0
    v_mov_b32 v27, 0
    v_mov_b32 v28, 0
    v_mov_b32 v29, 0
    v_mov_b32 v152, 0x3f803f80
    s_lshl_b32 s44, s51, 4
    s_add_u32 s44, s44, 22016
    v_lshl_add_u32 v197, v1, 3, s44
    v_lshl_add_u32 v30, v192, 6, v197
    v_lshl_add_u32 v31, v193, 6, v197
    v_and_b32 v193, 15, v207
    v_lshlrev_b32 v193, 1, v193
    v_lshrrev_b32 v193, v193, s55
    v_and_b32 v9, 1, v193
    v_bfe_u32 v193, v193, 1, 1
    v_lshl_or_b32 v9, v193, 16, v9
    s_waitcnt vmcnt(8)
    s_mov_b32 s71, 0
L_gcH:
    v_cmp_ne_u32 vcc, s55, v151
    s_nop 1
    s_or_b32 s47, vcc_lo, vcc_hi
    s_cbranch_scc0 L_ggH
    s_add_u32 s71, s71, 1
    s_cmp_ge_u32 s71, 0x40000
    s_cbranch_scc1 L_ggH
    s_sleep 4
    buffer_load_dword v151, v154, s[20:23], s79 offen offset:512 sc1
    s_waitcnt vmcnt(0)
    s_branch L_gcH
L_ggH:
    s_cmp_eq_u32 s71, 0
    s_cbranch_scc1 L_gbH
    s_sleep 11
L_gbH:
    global_load_dword v32, v10, s[6:7] offset:-2048 sc1
    global_load_dword v33, v10, s[6:7] offset:-768 sc1
    global_load_dword v34, v10, s[6:7] offset:512 sc1
    global_load_dword v35, v10, s[6:7] offset:1792 sc1
    global_load_dword v36, v11, s[6:7] offset:-2048 sc1
    global_load_dword v37, v11, s[6:7] offset:-768 sc1
    global_load_dword v38, v11, s[6:7] offset:512 sc1
    global_load_dword v39, v11, s[6:7] offset:1792 sc1
    global_load_dword v40, v12, s[6:7] offset:-2048 sc1
    global_load_dword v41, v12, s[6:7] offset:-768 sc1
    global_load_dword v42, v12, s[6:7] offset:512 sc1
    global_load_dword v43, v12, s[6:7] offset:1792 sc1
    global_load_dword v44, v13, s[6:7] offset:-2048 sc1
    global_load_dword v45, v13, s[6:7] offset:-768 sc1
    global_load_dword v46, v13, s[6:7] offset:512 sc1
    global_load_dword v47, v13, s[6:7] offset:1792 sc1
    global_load_dword v48, v10, s[6:7] offset:-1920 sc1
    global_load_dword v49, v10, s[6:7] offset:-640 sc1
    global_load_dword v50, v10, s[6:7] offset:640 sc1
    global_load_dword v51, v10, s[6:7] offset:1920 sc1
    global_load_dword v52, v11, s[6:7] offset:-1920 sc1
    global_load_dword v53, v11, s[6:7] offset:-640 sc1
    global_load_dword v54, v11, s[6:7] offset:640 sc1
    global_load_dword v55, v11, s[6:7] offset:1920 sc1
    global_load_dword v56, v12, s[6:7] offset:-1920 sc1
    global_load_dword v57, v12, s[6:7] offset:-640 sc1
    global_load_dword v58, v12, s[6:7] offset:640 sc1
    global_load_dword v59, v12, s[6:7] offset:1920 sc1
    global_load_dword v60, v13, s[6:7] offset:-1920 sc1
    global_load_dword v61, v13, s[6:7] offset:-640 sc1
    global_load_dword v62, v13, s[6:7] offset:640 sc1
    global_load_dword v63, v13, s[6:7] offset:1920 sc1
    global_load_dword v64, v10, s[6:7] offset:-1792 sc1
    global_load_dword v65, v10, s[6:7] offset:-512 sc1
    global_load_dword v66, v10, s[6:7] offset:768 sc1
    global_load_dword v67, v10, s[6:7] offset:2048 sc1
    global_load_dword v68, v11, s[6:7] offset:-1792 sc1
    global_load_dword v69, v11, s[6:7] offset:-512 sc1
    global_load_dword v70, v11, s[6:7] offset:768 sc1
    global_load_dword v71, v11, s[6:7] offset:2048 sc1
    global_load_dword v72, v12, s[6:7] offset:-1792 sc1
    global_load_dword v73, v12, s[6:7] offset:-512 sc1
    global_load_dword v74, v12, s[6:7] offset:768 sc1
    global_load_dword v75, v12, s[6:7] offset:2048 sc1
    global_load_dword v76, v13, s[6:7] offset:-1792 sc1
    global_load_dword v77, v13, s[6:7] offset:-512 sc1
    global_load_dword v78, v13, s[6:7] offset:768 sc1
    global_load_dword v79, v13, s[6:7] offset:2048 sc1
L_join2:
    s_mov_b32 s46, 0
    ds_read_b128 v[112:115], v18 offset:0
    global_load_dword v80, v10, s[6:7] offset:-1664 sc1
    global_load_dword v81, v10, s[6:7] offset:-384 sc1
    global_load_dword v82, v10, s[6:7] offset:896 sc1
    global_load_dword v83, v10, s[6:7] offset:2176 sc1
    ds_read_b128 v[116:119], v19 offset:0
    ds_read_b128 v[120:123], v20 offset:57344
    ds_read_b128 v[124:127], v21 offset:57344
    ds_read_u16_d16_hi v128, v23 offset:57344
    s_waitcnt vmcnt(36)
    v_xor_b32 v32, v9, v32
    v_xor_b32 v33, v9, v33
    v_xor_b32 v34, v9, v34
    v_xor_b32 v35, v9, v35
    v_or3_b32 v153, v32, v33, v34
    v_xor_b32 v36, v9, v36
    global_load_dword v84, v11, s[6:7] offset:-1664 sc1
    global_load_dword v85, v11, s[6:7] offset:-384 sc1
    global_load_dword v86, v11, s[6:7] offset:896 sc1
    global_load_dword v87, v11, s[6:7] offset:2176 sc1
    v_xor_b32 v37, v9, v37
    v_or3_b32 v153, v153, v35, v36
    v_xor_b32 v38, v9, v38
    v_xor_b32 v39, v9, v39
    v_or3_b32 v153, v153, v37, v38
    v_xor_b32 v40, v9, v40
    v_xor_b32 v41, v9, v41
    v_or3_b32 v153, v153, v39, v40
    global_load_dword v88, v12, s[6:7] offset:-1664 sc1
    global_load_dword v89, v12, s[6:7] offset:-384 sc1
    global_load_dword v90, v12, s[6:7] offset:896 sc1
    global_load_dword v91, v12, s[6:7] offset:2176 sc1
    v_xor_b32 v42, v9, v42
    v_xor_b32 v43, v9, v43
    v_or3_b32 v153, v153, v41, v42
    v_xor_b32 v44, v9, v44
    v_xor_b32 v45, v9, v45
    v_or3_b32 v153, v153, v43, v44
    v_xor_b32 v46, v9, v46
    v_xor_b32 v47, v9, v47
    global_load_dword v92, v13, s[6:7] offset:-1664 sc1
    global_load_dword v93, v13, s[6:7] offset:-384 sc1
    global_load_dword v94, v13, s[6:7] offset:896 sc1
    global_load_dword v95, v13, s[6:7] offset:2176 sc1
    v_or3_b32 v153, v153, v45, v46
    v_or_b32 v153, v153, v47
    v_and_b32 v153, 0x10001, v153
    v_cmp_ne_u32 vcc, 0, v153
    s_cbranch_vccnz L_vsz0
L_vgz0:
    v_mfma_f32_32x32x16_f16 v[192:207], v[32:35], v[160:163], 0
    v_mfma_f32_32x32x16_f16 v[192:207], v[36:39], v[164:167], v[192:207]
    global_load_dword v96, v10, s[6:7] offset:-1536 sc1
    global_load_dword v97, v10, s[6:7] offset:-256 sc1
    global_load_dword v98, v10, s[6:7] offset:1024 sc1
    global_load_dword v99, v10, s[6:7] offset:2304 sc1
    s_waitcnt vmcnt(36)
    v_xor_b32 v48, v9, v48
    v_xor_b32 v49, v9, v49
    v_xor_b32 v50, v9, v50
    v_xor_b32 v51, v9, v51
    v_mfma_f32_32x32x16_f16 v[192:207], v[40:43], v[168:171], v[192:207]
    v_or3_b32 v153, v48, v49, v50
    global_load_dword v100, v11, s[6:7] offset:-1536 sc1
    global_load_dword v101, v11, s[6:7] offset:-256 sc1
    global_load_dword v102, v11, s[6:7] offset:1024 sc1
    global_load_dword v103, v11, s[6:7] offset:2304 sc1
    v_xor_b32 v52, v9, v52
    v_xor_b32 v53, v9, v53
    v_or3_b32 v153, v153, v51, v52
    v_xor_b32 v54, v9, v54
    v_mfma_f32_32x32x16_f16 v[192:207], v[44:47], v[172:175], v[192:207]
    v_xor_b32 v55, v9, v55
    v_or3_b32 v153, v153, v53, v54
    global_load_dword v104, v12, s[6:7] offset:-1536 sc1
    global_load_dword v105, v12, s[6:7] offset:-256 sc1
    global_load_dword v106, v12, s[6:7] offset:1024 sc1
    global_load_dword v107, v12, s[6:7] offset:2304 sc1
    v_xor_b32 v56, v9, v56
    v_xor_b32 v57, v9, v57
    v_or3_b32 v153, v153, v55, v56
    s_waitcnt lgkmcnt(0)
    v_mfma_f32_32x32x16_bf16 v[208:223], v[176:179], v[112:115], v[192:207]
    v_xor_b32 v58, v9, v58
    v_xor_b32 v59, v9, v59
    global_load_dword v108, v13, s[6:7] offset:-1536 sc1
    global_load_dword v109, v13, s[6:7] offset:-256 sc1
    global_load_dword v110, v13, s[6:7] offset:1024 sc1
    global_load_dword v111, v13, s[6:7] offset:2304 sc1
    v_or3_b32 v153, v153, v57, v58
    v_xor_b32 v60, v9, v60
    v_xor_b32 v61, v9, v61
    v_mfma_f32_32x32x16_bf16 v[192:207], v[184:187], v[120:123], v[192:207]
    v_or3_b32 v153, v153, v59, v60
    v_xor_b32 v62, v9, v62
    v_xor_b32 v63, v9, v63
    s_add_u32 s18, s10, 4096
    buffer_load_dwordx4 a[72:75], v3, s[36:39], s18 offen offset:0 sc1
    v_or3_b32 v153, v153, v61, v62
    v_or_b32 v153, v153, v63
    v_mfma_f32_32x32x16_bf16 v[208:223], v[180:183], v[116:119], v[208:223]
    v_and_b32 v153, 0x10001, v153
    v_cmp_ne_u32 vcc, 0, v153
    s_cbranch_vccnz L_vsz1
L_vgz1:
    v_mfma_f32_32x32x16_bf16 v[192:207], v[188:191], v[124:127], v[192:207]
    v_mfma_f32_32x32x16_f16 v[224:239], v[48:51], v[160:163], 0
    s_add_u32 s19, s11, 4096
    buffer_load_dwordx4 a[76:79], v3, s[36:39], s19 offen offset:0 sc1
    ds_read_b128 v[132:135], v18 offset:4096
    ds_read_b128 v[136:139], v19 offset:4096
    ds_read_b128 v[140:143], v20 offset:53248
    ds_read_b128 v[144:147], v21 offset:53248
    ds_read_u16_d16_hi v148, v22 offset:53248
    v_mfma_f32_32x32x16_f16 v[224:239], v[52:55], v[164:167], v[224:239]
    s_nop 2
    v_fmac_f32 v208, v24, v192
    buffer_load_dwordx4 a[80:83], v3, s[36:39], s12 offen offset:1024 sc1
    v_fmac_f32 v192, v25, v128
    v_cvt_pk_bf16_f32 v32, v208, v209
    v_cvt_pk_bf16_f32 v33, v210, v211
    v_cvt_pk_bf16_f32 v34, v212, v213
    v_mfma_f32_32x32x16_f16 v[224:239], v[56:59], v[168:171], v[224:239]
    v_cvt_pk_bf16_f32 v35, v214, v215
    ds_write_b128 v14, v[32:35] offset:0
    v_cvt_pk_bf16_f32 v36, v216, v217
    buffer_load_dwordx4 a[84:87], v3, s[36:39], s13 offen offset:1024 sc1
    v_cvt_pk_bf16_f32 v37, v218, v219
    v_cvt_pk_bf16_f32 v38, v220, v221
    v_mfma_f32_32x32x16_f16 v[224:239], v[60:63], v[172:175], v[224:239]
    v_cvt_pk_bf16_f32 v39, v222, v223
    ds_write_b128 v15, v[36:39] offset:0
    v_cvt_pk_bf16_f32 v40, v207, v206
    v_cvt_pk_bf16_f32 v41, v205, v204
    v_cvt_pk_bf16_f32 v42, v203, v202
    buffer_load_dwordx4 a[88:91], v3, s[36:39], s18 offen offset:1024 sc1
    s_waitcnt lgkmcnt(5)
    v_mfma_f32_32x32x16_bf16 v[240:255], v[176:179], v[132:135], v[224:239]
    v_cvt_pk_bf16_f32 v43, v201, v200
    ds_write_b128 v16, v[40:43] offset:16384
    v_cvt_pk_bf16_f32 v44, v199, v198
    v_cvt_pk_bf16_f32 v45, v197, v196
    v_cvt_pk_bf16_f32 v46, v195, v194
    s_waitcnt lgkmcnt(3)
    v_mfma_f32_32x32x16_bf16 v[224:239], v[184:187], v[140:143], v[224:239]
    buffer_load_dwordx4 a[92:95], v3, s[36:39], s19 offen offset:1024 sc1
    v_cvt_pk_bf16_f32 v47, v193, v192
    ds_write_b128 v17, v[44:47] offset:16384
    s_waitcnt vmcnt(38)
    v_xor_b32 v64, v9, v64
    v_xor_b32 v65, v9, v65
    v_mfma_f32_32x32x16_bf16 v[240:255], v[180:183], v[136:139], v[240:255]
    v_xor_b32 v66, v9, v66
    buffer_load_dwordx4 a[96:99], v3, s[36:39], s12 offen offset:2048 sc1
    v_xor_b32 v67, v9, v67
    v_or3_b32 v153, v64, v65, v66
    v_xor_b32 v68, v9, v68
    v_xor_b32 v69, v9, v69
    v_mfma_f32_32x32x16_bf16 v[224:239], v[188:191], v[144:147], v[224:239]
    v_or3_b32 v153, v153, v67, v68
    v_xor_b32 v70, v9, v70
    v_xor_b32 v71, v9, v71
    v_or3_b32 v153, v153, v69, v70
    v_xor_b32 v72, v9, v72
    v_xor_b32 v73, v9, v73
    v_or3_b32 v153, v153, v71, v72
    v_xor_b32 v74, v9, v74
    buffer_load_dwordx4 a[100:103], v3, s[36:39], s13 offen offset:2048 sc1
    v_xor_b32 v75, v9, v75
    v_or3_b32 v153, v153, v73, v74
    v_xor_b32 v76, v9, v76
    v_xor_b32 v77, v9, v77
    v_or3_b32 v153, v153, v75, v76
    v_xor_b32 v78, v9, v78
    v_xor_b32 v79, v9, v79
    v_or3_b32 v153, v153, v77, v78
    v_or_b32 v153, v153, v79
    v_and_b32 v153, 0x10001, v153
    v_cmp_ne_u32 vcc, 0, v153
    s_cbranch_vccnz L_vsz2
L_vgz2:
    v_dot2c_f32_bf16 v26, v32, v152
    buffer_load_dwordx4 a[104:107], v3, s[36:39], s18 offen offset:2048 sc1
    v_dot2c_f32_bf16 v27, v32, v32
    v_dot2c_f32_bf16 v28, v40, v152
    v_dot2c_f32_bf16 v29, v40, v40
    v_dot2c_f32_bf16 v26, v33, v152
    v_dot2c_f32_bf16 v27, v33, v33
    v_dot2c_f32_bf16 v28, v41, v152
    v_dot2c_f32_bf16 v29, v41, v41
    v_dot2c_f32_bf16 v26, v34, v152
    v_dot2c_f32_bf16 v27, v34, v34
    v_dot2c_f32_bf16 v28, v42, v152
    v_dot2c_f32_bf16 v29, v42, v42
    v_dot2c_f32_bf16 v26, v35, v152
    v_dot2c_f32_bf16 v27, v35, v35
    v_dot2c_f32_bf16 v28, v43, v152
    buffer_load_dwordx4 a[108:111], v3, s[36:39], s19 offen offset:2048 sc1
    v_dot2c_f32_bf16 v29, v43, v43
    v_dot2c_f32_bf16 v26, v36, v152
    v_dot2c_f32_bf16 v27, v36, v36
    v_dot2c_f32_bf16 v28, v44, v152
    v_dot2c_f32_bf16 v29, v44, v44
    v_dot2c_f32_bf16 v26, v37, v152
    v_dot2c_f32_bf16 v27, v37, v37
    v_dot2c_f32_bf16 v28, v45, v152
    v_dot2c_f32_bf16 v29, v45, v45
    v_dot2c_f32_bf16 v26, v38, v152
    v_dot2c_f32_bf16 v27, v38, v38
    v_dot2c_f32_bf16 v28, v46, v152
    v_dot2c_f32_bf16 v29, v46, v46
    buffer_load_dwordx4 a[112:115], v3, s[36:39], s12 offen offset:3072 sc1
    v_dot2c_f32_bf16 v26, v39, v152
    v_dot2c_f32_bf16 v27, v39, v39
    v_dot2c_f32_bf16 v28, v47, v152
    v_dot2c_f32_bf16 v29, v47, v47
    v_mfma_f32_32x32x16_f16 v[192:207], v[64:67], v[160:163], 0
    ds_read_b128 v[112:115], v18 offset:8192
    ds_read_b128 v[116:119], v19 offset:8192
    ds_read_b128 v[120:123], v20 offset:49152
    ds_read_b128 v[124:127], v21 offset:49152
    ds_read_u16_d16_hi v128, v22 offset:49152
    v_mfma_f32_32x32x16_f16 v[192:207], v[68:71], v[164:167], v[192:207]
    buffer_load_dwordx4 a[116:119], v3, s[36:39], s13 offen offset:3072 sc1
    v_fmac_f32 v224, v25, v148
    v_cvt_pk_bf16_f32 v48, v240, v241
    v_cvt_pk_bf16_f32 v49, v242, v243
    v_cvt_pk_bf16_f32 v50, v244, v245
    v_cvt_pk_bf16_f32 v51, v246, v247
    v_mfma_f32_32x32x16_f16 v[192:207], v[72:75], v[168:171], v[192:207]
    ds_write_b128 v14, v[48:51] offset:4096
    v_cvt_pk_bf16_f32 v52, v248, v249
    buffer_load_dwordx4 a[120:123], v3, s[36:39], s18 offen offset:3072 sc1
    v_cvt_pk_bf16_f32 v53, v250, v251
    v_cvt_pk_bf16_f32 v54, v252, v253
    v_cvt_pk_bf16_f32 v55, v254, v255
    v_mfma_f32_32x32x16_f16 v[192:207], v[76:79], v[172:175], v[192:207]
    ds_write_b128 v15, v[52:55] offset:4096
    v_cvt_pk_bf16_f32 v56, v239, v238
    v_cvt_pk_bf16_f32 v57, v237, v236
    v_cvt_pk_bf16_f32 v58, v235, v234
    v_cvt_pk_bf16_f32 v59, v233, v232
    buffer_load_dwordx4 a[124:127], v3, s[36:39], s19 offen offset:3072 sc1
    s_waitcnt lgkmcnt(5)
    v_mfma_f32_32x32x16_bf16 v[208:223], v[176:179], v[112:115], v[192:207]
    ds_write_b128 v16, v[56:59] offset:12288
    v_cvt_pk_bf16_f32 v60, v231, v230
    v_cvt_pk_bf16_f32 v61, v229, v228
    v_cvt_pk_bf16_f32 v62, v227, v226
    v_cvt_pk_bf16_f32 v63, v225, v224
    s_waitcnt lgkmcnt(3)
    v_mfma_f32_32x32x16_bf16 v[192:207], v[184:187], v[120:123], v[192:207]
    s_add_u32 s12, s8, 8192
    buffer_load_dwordx4 a[128:131], v3, s[36:39], s12 offen offset:0 sc1
    ds_write_b128 v17, v[60:63] offset:12288
    s_waitcnt vmcnt(31)
    v_xor_b32 v80, v9, v80
    v_xor_b32 v81, v9, v81
    v_xor_b32 v82, v9, v82
    v_mfma_f32_32x32x16_bf16 v[208:223], v[180:183], v[116:119], v[208:223]
    s_add_u32 s13, s9, 8192
    buffer_load_dwordx4 a[132:135], v3, s[36:39], s13 offen offset:0 sc1
    v_xor_b32 v83, v9, v83
    v_or3_b32 v153, v80, v81, v82
    v_xor_b32 v84, v9, v84
    v_xor_b32 v85, v9, v85
    v_or3_b32 v153, v153, v83, v84
    v_mfma_f32_32x32x16_bf16 v[192:207], v[188:191], v[124:127], v[192:207]
    v_xor_b32 v86, v9, v86
    v_xor_b32 v87, v9, v87
    v_or3_b32 v153, v153, v85, v86
    v_xor_b32 v88, v9, v88
    v_xor_b32 v89, v9, v89
    s_add_u32 s18, s10, 8192
    buffer_load_dwordx4 a[136:139], v3, s[36:39], s18 offen offset:0 sc1
    v_or3_b32 v153, v153, v87, v88
    v_xor_b32 v90, v9, v90
    v_xor_b32 v91, v9, v91
    v_or3_b32 v153, v153, v89, v90
    v_xor_b32 v92, v9, v92
    v_xor_b32 v93, v9, v93
    v_or3_b32 v153, v153, v91, v92
    v_xor_b32 v94, v9, v94
    v_xor_b32 v95, v9, v95
    v_or3_b32 v153, v153, v93, v94
    v_or_b32 v153, v153, v95
    v_and_b32 v153, 0x10001, v153
    v_cmp_ne_u32 vcc, 0, v153
    s_cbranch_vccnz L_vsz3
L_vgz3:
    v_dot2c_f32_bf16 v26, v48, v152
    s_add_u32 s19, s11, 8192
    buffer_load_dwordx4 a[140:143], v3, s[36:39], s19 offen offset:0 sc1
    v_dot2c_f32_bf16 v27, v48, v48
    v_dot2c_f32_bf16 v28, v56, v152
    v_dot2c_f32_bf16 v29, v56, v56
    v_dot2c_f32_bf16 v26, v49, v152
    v_dot2c_f32_bf16 v27, v49, v49
    v_dot2c_f32_bf16 v28, v57, v152
    v_dot2c_f32_bf16 v29, v57, v57
    v_dot2c_f32_bf16 v26, v50, v152
    v_dot2c_f32_bf16 v27, v50, v50
    v_dot2c_f32_bf16 v28, v58, v152
    buffer_load_dwordx4 a[144:147], v3, s[36:39], s12 offen offset:1024 sc1
    v_dot2c_f32_bf16 v29, v58, v58
    v_dot2c_f32_bf16 v26, v51, v152
    v_dot2c_f32_bf16 v27, v51, v51
    v_dot2c_f32_bf16 v28, v59, v152
    v_dot2c_f32_bf16 v29, v59, v59
    v_dot2c_f32_bf16 v26, v52, v152
    v_dot2c_f32_bf16 v27, v52, v52
    v_dot2c_f32_bf16 v28, v60, v152
    v_dot2c_f32_bf16 v29, v60, v60
    v_dot2c_f32_bf16 v26, v53, v152
    v_dot2c_f32_bf16 v27, v53, v53
    v_dot2c_f32_bf16 v28, v61, v152
    v_dot2c_f32_bf16 v29, v61, v61
    buffer_load_dwordx4 a[148:151], v3, s[36:39], s13 offen offset:1024 sc1
    v_dot2c_f32_bf16 v26, v54, v152
    v_dot2c_f32_bf16 v27, v54, v54
    v_dot2c_f32_bf16 v28, v62, v152
    v_dot2c_f32_bf16 v29, v62, v62
    v_dot2c_f32_bf16 v26, v55, v152
    v_dot2c_f32_bf16 v27, v55, v55
    v_dot2c_f32_bf16 v28, v63, v152
    v_dot2c_f32_bf16 v29, v63, v63
    v_mfma_f32_32x32x16_f16 v[224:239], v[80:83], v[160:163], 0
    ds_read_b128 v[132:135], v18 offset:12288
    ds_read_b128 v[136:139], v19 offset:12288
    ds_read_b128 v[140:143], v20 offset:45056
    ds_read_b128 v[144:147], v21 offset:45056
    ds_read_u16_d16_hi v148, v22 offset:45056
    v_mfma_f32_32x32x16_f16 v[224:239], v[84:87], v[164:167], v[224:239]
    buffer_load_dwordx4 a[152:155], v3, s[36:39], s18 offen offset:1024 sc1
    v_fmac_f32 v192, v25, v128
    v_cvt_pk_bf16_f32 v64, v208, v209
    v_cvt_pk_bf16_f32 v65, v210, v211
    v_cvt_pk_bf16_f32 v66, v212, v213
    v_cvt_pk_bf16_f32 v67, v214, v215
    v_mfma_f32_32x32x16_f16 v[224:239], v[88:91], v[168:171], v[224:239]
    ds_write_b128 v14, v[64:67] offset:8192
    buffer_load_dwordx4 a[156:159], v3, s[36:39], s19 offen offset:1024 sc1
    v_cvt_pk_bf16_f32 v68, v216, v217
    v_cvt_pk_bf16_f32 v69, v218, v219
    v_cvt_pk_bf16_f32 v70, v220, v221
    v_cvt_pk_bf16_f32 v71, v222, v223
    v_mfma_f32_32x32x16_f16 v[224:239], v[92:95], v[172:175], v[224:239]
    ds_write_b128 v15, v[68:71] offset:8192
    s_add_u32 s12, s68, 0
    buffer_load_dwordx4 a[160:163], v3, s[36:39], s12 offen offset:0 sc1
    v_cvt_pk_bf16_f32 v72, v207, v206
    v_cvt_pk_bf16_f32 v73, v205, v204
    v_cvt_pk_bf16_f32 v74, v203, v202
    v_cvt_pk_bf16_f32 v75, v201, v200
    s_waitcnt lgkmcnt(5)
    v_mfma_f32_32x32x16_bf16 v[240:255], v[176:179], v[132:135], v[224:239]
    ds_write_b128 v16, v[72:75] offset:8192
    v_cvt_pk_bf16_f32 v76, v199, v198
    s_add_u32 s13, s69, 0
    buffer_load_dwordx4 a[164:167], v3, s[36:39], s13 offen offset:0 sc1
    v_cvt_pk_bf16_f32 v77, v197, v196
    v_cvt_pk_bf16_f32 v78, v195, v194
    v_cvt_pk_bf16_f32 v79, v193, v192
    s_waitcnt lgkmcnt(3)
    v_mfma_f32_32x32x16_bf16 v[224:239], v[184:187], v[140:143], v[224:239]
    ds_write_b128 v17, v[76:79] offset:8192
    s_waitcnt vmcnt(24)
    v_xor_b32 v96, v9, v96
    s_add_u32 s18, s70, 0
    buffer_load_dwordx4 a[168:171], v3, s[36:39], s18 offen offset:0 sc1
    v_xor_b32 v97, v9, v97
    v_xor_b32 v98, v9, v98
    v_mfma_f32_32x32x16_bf16 v[240:255], v[180:183], v[136:139], v[240:255]
    v_xor_b32 v99, v9, v99
    v_or3_b32 v153, v96, v97, v98
    v_xor_b32 v100, v9, v100
    v_xor_b32 v101, v9, v101
    v_or3_b32 v153, v153, v99, v100
    v_mfma_f32_32x32x16_bf16 v[224:239], v[188:191], v[144:147], v[224:239]
    buffer_load_dwordx4 a[172:175], v3, s[36:39], s12 offen offset:1024 sc1
    v_xor_b32 v102, v9, v102
    v_xor_b32 v103, v9, v103
    v_or3_b32 v153, v153, v101, v102
    v_xor_b32 v104, v9, v104
    v_xor_b32 v105, v9, v105
    v_or3_b32 v153, v153, v103, v104
    v_xor_b32 v106, v9, v106
    v_xor_b32 v107, v9, v107
    v_or3_b32 v153, v153, v105, v106
    v_xor_b32 v108, v9, v108
    v_xor_b32 v109, v9, v109
    v_or3_b32 v153, v153, v107, v108
    v_xor_b32 v110, v9, v110
    buffer_load_dwordx4 a[176:179], v3, s[36:39], s13 offen offset:1024 sc1
    v_xor_b32 v111, v9, v111
    v_or3_b32 v153, v153, v109, v110
    v_or_b32 v153, v153, v111
    v_and_b32 v153, 0x10001, v153
    v_cmp_ne_u32 vcc, 0, v153
    s_cbranch_vccnz L_vsz4
L_vgz4:
    buffer_load_dwordx4 v[156:159], v155, s[20:23], s79 offen sc1
    v_dot2c_f32_bf16 v26, v64, v152
    v_dot2c_f32_bf16 v27, v64, v64
    v_dot2c_f32_bf16 v28, v72, v152
    v_dot2c_f32_bf16 v29, v72, v72
    v_dot2c_f32_bf16 v26, v65, v152
    v_dot2c_f32_bf16 v27, v65, v65
    buffer_load_dwordx4 a[180:183], v3, s[36:39], s18 offen offset:1024 sc1
    v_dot2c_f32_bf16 v28, v73, v152
    v_dot2c_f32_bf16 v29, v73, v73
    v_dot2c_f32_bf16 v26, v66, v152
    v_dot2c_f32_bf16 v27, v66, v66
    v_dot2c_f32_bf16 v28, v74, v152
    v_dot2c_f32_bf16 v29, v74, v74
    v_dot2c_f32_bf16 v26, v67, v152
    v_dot2c_f32_bf16 v27, v67, v67
    v_dot2c_f32_bf16 v28, v75, v152
    v_dot2c_f32_bf16 v29, v75, v75
    v_dot2c_f32_bf16 v26, v68, v152
    v_dot2c_f32_bf16 v27, v68, v68
    v_dot2c_f32_bf16 v28, v76, v152
    buffer_load_dwordx4 a[184:187], v3, s[36:39], s12 offen offset:2048 sc1
    v_dot2c_f32_bf16 v29, v76, v76
    v_dot2c_f32_bf16 v26, v69, v152
    v_dot2c_f32_bf16 v27, v69, v69
    v_dot2c_f32_bf16 v28, v77, v152
    v_dot2c_f32_bf16 v29, v77, v77
    v_dot2c_f32_bf16 v26, v70, v152
    v_dot2c_f32_bf16 v27, v70, v70
    v_dot2c_f32_bf16 v28, v78, v152
    v_dot2c_f32_bf16 v29, v78, v78
    v_dot2c_f32_bf16 v26, v71, v152
    v_dot2c_f32_bf16 v27, v71, v71
    v_dot2c_f32_bf16 v28, v79, v152
    v_dot2c_f32_bf16 v29, v79, v79
    buffer_load_dwordx4 a[188:191], v3, s[36:39], s13 offen offset:2048 sc1
    v_mfma_f32_32x32x16_f16 v[192:207], v[96:99], v[160:163], 0
    ds_read_b128 v[112:115], v18 offset:16384
    ds_read_b128 v[116:119], v19 offset:16384
    ds_read_b128 v[120:123], v20 offset:40960
    ds_read_b128 v[124:127], v21 offset:40960
    ds_read_u16_d16_hi v128, v22 offset:40960
    v_mfma_f32_32x32x16_f16 v[192:207], v[100:103], v[164:167], v[192:207]
    v_fmac_f32 v224, v25, v148
    v_cvt_pk_bf16_f32 v80, v240, v241
    v_cvt_pk_bf16_f32 v81, v242, v243
    v_cvt_pk_bf16_f32 v82, v244, v245
    buffer_load_dwordx4 a[192:195], v3, s[36:39], s18 offen offset:2048 sc1
    v_cvt_pk_bf16_f32 v83, v246, v247
    v_mfma_f32_32x32x16_f16 v[192:207], v[104:107], v[168:171], v[192:207]
    ds_write_b128 v14, v[80:83] offset:12288
    v_cvt_pk_bf16_f32 v84, v248, v249
    v_cvt_pk_bf16_f32 v85, v250, v251
    v_cvt_pk_bf16_f32 v86, v252, v253
    v_cvt_pk_bf16_f32 v87, v254, v255
    v_mfma_f32_32x32x16_f16 v[192:207], v[108:111], v[172:175], v[192:207]
    buffer_load_dwordx4 a[196:199], v3, s[36:39], s12 offen offset:3072 sc1
    ds_write_b128 v15, v[84:87] offset:12288
    v_cvt_pk_bf16_f32 v88, v239, v238
    v_cvt_pk_bf16_f32 v89, v237, v236
    v_cvt_pk_bf16_f32 v90, v235, v234
    v_cvt_pk_bf16_f32 v91, v233, v232
    s_waitcnt lgkmcnt(5)
    v_mfma_f32_32x32x16_bf16 v[208:223], v[176:179], v[112:115], v[192:207]
    ds_write_b128 v16, v[88:91] offset:4096
    buffer_load_dwordx4 a[200:203], v3, s[36:39], s13 offen offset:3072 sc1
    v_cvt_pk_bf16_f32 v92, v231, v230
    v_cvt_pk_bf16_f32 v93, v229, v228
    v_cvt_pk_bf16_f32 v94, v227, v226
    v_cvt_pk_bf16_f32 v95, v225, v224
    s_waitcnt lgkmcnt(3)
    v_mfma_f32_32x32x16_bf16 v[192:207], v[184:187], v[120:123], v[192:207]
    ds_write_b128 v17, v[92:95] offset:4096
    buffer_load_dwordx4 a[204:207], v3, s[36:39], s18 offen offset:3072 sc1
    v_mfma_f32_32x32x16_bf16 v[208:223], v[180:183], v[116:119], v[208:223]
    v_mfma_f32_32x32x16_bf16 v[192:207], v[188:191], v[124:127], v[192:207]
    v_dot2c_f32_bf16 v26, v80, v152
    s_add_u32 s12, s68, 4096
    buffer_load_dwordx4 a[208:211], v3, s[36:39], s12 offen offset:0 sc1
    v_dot2c_f32_bf16 v27, v80, v80
    v_dot2c_f32_bf16 v28, v88, v152
    v_dot2c_f32_bf16 v29, v88, v88
    v_dot2c_f32_bf16 v26, v81, v152
    v_dot2c_f32_bf16 v27, v81, v81
    v_dot2c_f32_bf16 v28, v89, v152
    v_dot2c_f32_bf16 v29, v89, v89
    v_dot2c_f32_bf16 v26, v82, v152
    s_add_u32 s13, s69, 4096
    buffer_load_dwordx4 a[212:215], v3, s[36:39], s13 offen offset:0 sc1
    v_dot2c_f32_bf16 v27, v82, v82
    v_dot2c_f32_bf16 v28, v90, v152
    v_dot2c_f32_bf16 v29, v90, v90
    v_dot2c_f32_bf16 v26, v83, v152
    v_dot2c_f32_bf16 v27, v83, v83
    v_dot2c_f32_bf16 v28, v91, v152
    v_dot2c_f32_bf16 v29, v91, v91
    v_dot2c_f32_bf16 v26, v84, v152
    v_dot2c_f32_bf16 v27, v84, v84
    v_dot2c_f32_bf16 v28, v92, v152
    v_dot2c_f32_bf16 v29, v92, v92
    v_dot2c_f32_bf16 v26, v85, v152
    v_dot2c_f32_bf16 v27, v85, v85
    s_add_u32 s18, s70, 4096
    buffer_load_dwordx4 a[216:219], v3, s[36:39], s18 offen offset:0 sc1
    v_dot2c_f32_bf16 v28, v93, v152
    v_dot2c_f32_bf16 v29, v93, v93
    v_dot2c_f32_bf16 v26, v86, v152
    v_dot2c_f32_bf16 v27, v86, v86
    v_dot2c_f32_bf16 v28, v94, v152
    v_dot2c_f32_bf16 v29, v94, v94
    v_dot2c_f32_bf16 v26, v87, v152
    v_dot2c_f32_bf16 v27, v87, v87
    v_dot2c_f32_bf16 v28, v95, v152
    v_dot2c_f32_bf16 v29, v95, v95
    v_fmac_f32 v192, v25, v128
    v_cvt_pk_bf16_f32 v96, v208, v209
    buffer_load_dwordx4 a[220:223], v3, s[36:39], s12 offen offset:1024 sc1
    v_cvt_pk_bf16_f32 v97, v210, v211
    v_cvt_pk_bf16_f32 v98, v212, v213
    v_cvt_pk_bf16_f32 v99, v214, v215
    ds_write_b128 v14, v[96:99] offset:16384
    v_cvt_pk_bf16_f32 v100, v216, v217
    v_cvt_pk_bf16_f32 v101, v218, v219
    v_cvt_pk_bf16_f32 v102, v220, v221
    v_cvt_pk_bf16_f32 v103, v222, v223
    ds_write_b128 v15, v[100:103] offset:16384
    buffer_load_dwordx4 a[224:227], v3, s[36:39], s13 offen offset:1024 sc1
    v_cvt_pk_bf16_f32 v104, v207, v206
    v_cvt_pk_bf16_f32 v105, v205, v204
    v_cvt_pk_bf16_f32 v106, v203, v202
    v_cvt_pk_bf16_f32 v107, v201, v200
    ds_write_b128 v16, v[104:107] offset:0
    v_cvt_pk_bf16_f32 v108, v199, v198
    buffer_load_dwordx4 a[228:231], v3, s[36:39], s18 offen offset:1024 sc1
    v_cvt_pk_bf16_f32 v109, v197, v196
    v_cvt_pk_bf16_f32 v110, v195, v194
    v_cvt_pk_bf16_f32 v111, v193, v192
    ds_write_b128 v17, v[108:111] offset:0
    v_dot2c_f32_bf16 v26, v96, v152
    v_dot2c_f32_bf16 v27, v96, v96
    v_dot2c_f32_bf16 v28, v104, v152
    v_dot2c_f32_bf16 v29, v104, v104
    v_dot2c_f32_bf16 v26, v97, v152
    buffer_load_dwordx4 a[232:235], v3, s[36:39], s12 offen offset:2048 sc1
    v_dot2c_f32_bf16 v27, v97, v97
    v_dot2c_f32_bf16 v28, v105, v152
    v_dot2c_f32_bf16 v29, v105, v105
    v_dot2c_f32_bf16 v26, v98, v152
    v_dot2c_f32_bf16 v27, v98, v98
    v_dot2c_f32_bf16 v28, v106, v152
    v_dot2c_f32_bf16 v29, v106, v106
    v_dot2c_f32_bf16 v26, v99, v152
    v_dot2c_f32_bf16 v27, v99, v99
    v_dot2c_f32_bf16 v28, v107, v152
    v_dot2c_f32_bf16 v29, v107, v107
    v_dot2c_f32_bf16 v26, v100, v152
    v_dot2c_f32_bf16 v27, v100, v100
    buffer_load_dwordx4 a[236:239], v3, s[36:39], s13 offen offset:2048 sc1
    v_dot2c_f32_bf16 v28, v108, v152
    v_dot2c_f32_bf16 v29, v108, v108
    v_dot2c_f32_bf16 v26, v101, v152
    v_dot2c_f32_bf16 v27, v101, v101
    v_dot2c_f32_bf16 v28, v109, v152
    v_dot2c_f32_bf16 v29, v109, v109
    v_dot2c_f32_bf16 v26, v102, v152
    v_dot2c_f32_bf16 v27, v102, v102
    v_dot2c_f32_bf16 v28, v110, v152
    v_dot2c_f32_bf16 v29, v110, v110
    v_dot2c_f32_bf16 v26, v103, v152
    v_dot2c_f32_bf16 v27, v103, v103
    v_dot2c_f32_bf16 v28, v111, v152
    v_dot2c_f32_bf16 v29, v111, v111
    buffer_load_dwordx4 a[240:243], v3, s[36:39], s18 offen offset:2048 sc1
    ds_write_b64 v30, v[26:27]
    s_nop 0
    ds_write_b64 v31, v[28:29] offset:32
    s_waitcnt vmcnt(16)
    s_mov_b32 s45, 0
L_gcX:
    v_xor_b32 v156, s55, v156
    v_xor_b32 v157, s55, v157
    v_xor_b32 v158, s55, v158
    v_xor_b32 v159, s55, v159
    v_or_b32 v156, v156, v157
    v_or3_b32 v156, v156, v158, v159
    v_cmp_ne_u32 vcc, 0, v156
    s_nop 1
    s_or_b32 s47, vcc_lo, vcc_hi
    s_cbranch_scc0 L_ggX
    s_add_u32 s45, s45, 1
    s_cmp_ge_u32 s45, 0x40000
    s_cbranch_scc1 L_ggX
    s_sleep 4
    buffer_load_dwordx4 v[156:159], v155, s[20:23], s79 offen sc1
    s_waitcnt vmcnt(0)
    s_branch L_gcX
L_ggX:
    s_waitcnt lgkmcnt(0)
    s_barrier
    s_mul_i32 s26, s3, 10240
    v_and_b32 v28, 32, v0
    v_lshl_add_u32 v28, v28, 25, v3
    ds_read_b128 v[160:163], v5 offset:0
    ds_read_b128 v[164:167], v6 offset:0
    ds_read_b128 v[168:171], v5 offset:4096
    ds_read_b128 v[172:175], v6 offset:4096
    s_waitcnt lgkmcnt(2)
    v_mfma_f32_16x16x32_bf16 v[192:195], a[0:3], v[160:163], 0
    ds_read_b128 v[176:179], v5 offset:8192
    buffer_load_dwordx4 a[244:247], v3, s[36:39], s12 offen offset:3072 sc1
    v_mfma_f32_16x16x32_bf16 v[200:203], a[4:7], v[160:163], 0
    v_and_b32 v1, 15, v0
    v_lshrrev_b32 v2, 4, v0
    v_mfma_f32_16x16x32_bf16 v[208:211], a[8:11], v[160:163], 0
    ds_read_b128 v[180:183], v6 offset:8192
    v_mul_u32_u24 v27, 13108, v0
    v_lshrrev_b32 v27, 16, v27
    v_mfma_f32_16x16x32_bf16 v[216:219], a[12:15], v[160:163], 0
    buffer_load_dwordx4 a[248:251], v3, s[36:39], s13 offen offset:3072 sc1
    v_mfma_f32_16x16x32_bf16 v[196:199], a[0:3], v[164:167], 0
    v_mul_u32_u24 v25, 5, v27
    v_sub_u32 v25, v0, v25
    v_mfma_f32_16x16x32_bf16 v[204:207], a[4:7], v[164:167], 0
    v_lshlrev_b32 v31, 4, v25
    v_mfma_f32_16x16x32_bf16 v[212:215], a[8:11], v[164:167], 0
    buffer_load_dwordx4 v[104:107], v31, s[28:31], s27 offen offset:0
    v_mfma_f32_16x16x32_bf16 v[220:223], a[12:15], v[164:167], 0
    s_waitcnt lgkmcnt(2)
    v_mfma_f32_16x16x32_bf16 v[192:195], a[16:19], v[168:171], v[192:195]
    ds_read_b128 v[184:187], v5 offset:12288
    buffer_load_dwordx4 a[252:255], v3, s[36:39], s18 offen offset:3072 sc1
    v_mfma_f32_16x16x32_bf16 v[200:203], a[20:23], v[168:171], v[200:203]
    v_mfma_f32_16x16x32_bf16 v[208:211], a[24:27], v[168:171], v[208:211]
    ds_read_b128 v[188:191], v6 offset:12288
    s_add_u32 s12, s68, 8192
    v_mfma_f32_16x16x32_bf16 v[216:219], a[28:31], v[168:171], v[216:219]
    buffer_load_dwordx4 v[32:35], v3, s[36:39], s12 offen offset:0 sc1
    v_mfma_f32_16x16x32_bf16 v[196:199], a[16:19], v[172:175], v[196:199]
    buffer_load_dwordx4 v[108:111], v31, s[28:31], s27 offen offset:80
    v_mfma_f32_16x16x32_bf16 v[204:207], a[20:23], v[172:175], v[204:207]
    v_mfma_f32_16x16x32_bf16 v[212:215], a[24:27], v[172:175], v[212:215]
    s_add_u32 s13, s69, 8192
    v_lshrrev_b32 v26, 3, v27
    v_mfma_f32_16x16x32_bf16 v[220:223], a[28:31], v[172:175], v[220:223]
    v_lshl_add_u32 v26, v26, 30, v31
    s_waitcnt lgkmcnt(2)
    v_mfma_f32_16x16x32_bf16 v[192:195], a[32:35], v[176:179], v[192:195]
    ds_read_b128 v[160:163], v5 offset:16384
    buffer_load_dwordx4 v[36:39], v3, s[36:39], s13 offen offset:0 sc1
    v_mfma_f32_16x16x32_bf16 v[200:203], a[36:39], v[176:179], v[200:203]
    v_min_u32 v27, 7, v27
    s_lshl_b32 s24, s3, 3
    v_mfma_f32_16x16x32_bf16 v[208:211], a[40:43], v[176:179], v[208:211]
    ds_read_b128 v[164:167], v6 offset:16384
    v_add_u32 v27, s24, v27
    s_mov_b32 s24, 81920
    v_mfma_f32_16x16x32_bf16 v[216:219], a[44:47], v[176:179], v[216:219]
    v_mad_u32_u24 v26, v27, s24, v26
    v_mul_u32_u24 v23, 336, v27
    v_mfma_f32_16x16x32_bf16 v[196:199], a[32:35], v[180:183], v[196:199]
    s_add_u32 s18, s70, 8192
    v_lshl_add_u32 v23, v25, 5, v23
    v_mfma_f32_16x16x32_bf16 v[204:207], a[36:39], v[180:183], v[204:207]
    buffer_load_dwordx4 v[40:43], v3, s[36:39], s18 offen offset:0 sc1
    v_mfma_f32_16x16x32_bf16 v[212:215], a[40:43], v[180:183], v[212:215]
    v_add_u32 v24, 83968, v23
    v_add_u32 v23, 40960, v23
    v_mfma_f32_16x16x32_bf16 v[220:223], a[44:47], v[180:183], v[220:223]
    s_lshl_b32 s24, s3, 10
    v_add_u32 v19, s24, v3
    s_waitcnt lgkmcnt(2)
    v_mfma_f32_16x16x32_bf16 v[192:195], a[48:51], v[184:187], v[192:195]
    ds_read_b128 v[168:171], v5 offset:20480
    buffer_load_dwordx4 v[44:47], v3, s[36:39], s12 offen offset:1024 sc1
    v_mfma_f32_16x16x32_bf16 v[200:203], a[52:55], v[184:187], v[200:203]
    v_xor_b32 v20, 1024, v19
    s_lshl_b32 s24, s51, 8
    v_mfma_f32_16x16x32_bf16 v[208:211], a[56:59], v[184:187], v[208:211]
    ds_read_b128 v[172:175], v6 offset:20480
    v_lshl_add_u32 v9, v1, 4, s24
    v_xor_b32 v10, 256, v9
    v_mfma_f32_16x16x32_bf16 v[216:219], a[60:63], v[184:187], v[216:219]
    s_lshl_b32 s24, s51, 10
    v_add_u32 v13, s24, v3
    v_mfma_f32_16x16x32_bf16 v[196:199], a[48:51], v[188:191], v[196:199]
    buffer_load_dwordx4 v[48:51], v3, s[36:39], s13 offen offset:1024 sc1
    v_mfma_f32_16x16x32_bf16 v[204:207], a[52:55], v[188:191], v[204:207]
    v_xor_b32 v14, 1024, v13
    v_and_b32 v18, 0x1ff, v3
    v_mfma_f32_16x16x32_bf16 v[212:215], a[56:59], v[188:191], v[212:215]
    v_and_b32 v31, 32, v0
    v_lshl_add_u32 v15, v31, 5, v18
    v_mfma_f32_16x16x32_bf16 v[220:223], a[60:63], v[188:191], v[220:223]
    s_mul_i32 s24, s51, 1536
    v_xor_b32 v15, s24, v15
    s_waitcnt lgkmcnt(2)
    v_mfma_f32_16x16x32_bf16 v[192:195], a[64:67], v[160:163], v[192:195]
    ds_read_b128 v[176:179], v5 offset:24576
    buffer_load_dwordx4 v[52:55], v3, s[36:39], s18 offen offset:1024 sc1
    v_mfma_f32_16x16x32_bf16 v[200:203], a[68:71], v[160:163], v[200:203]
    v_lshl_add_u32 v18, v31, 25, v18
    s_lshl_b32 s24, s51, 10
    v_mfma_f32_16x16x32_bf16 v[208:211], a[72:75], v[160:163], v[208:211]
    ds_read_b128 v[180:183], v6 offset:24576
    s_lshr_b32 s25, s3, 1
    s_lshl_b32 s25, s25, 9
    v_mfma_f32_16x16x32_bf16 v[216:219], a[76:79], v[160:163], v[216:219]
    s_add_u32 s24, s24, s25
    v_add_u32 v18, s24, v18
    v_mfma_f32_16x16x32_bf16 v[196:199], a[64:67], v[164:167], v[196:199]
    s_add_u32 s12, s8, s72
    v_and_b32 v31, 7, v0
    v_mfma_f32_16x16x32_bf16 v[204:207], a[68:71], v[164:167], v[204:207]
    buffer_load_dwordx4 v[56:59], v28, s[36:39], s12 offen offset:0 sc1
    v_mfma_f32_16x16x32_bf16 v[212:215], a[72:75], v[164:167], v[212:215]
    v_lshlrev_b32 v31, 2, v31
    v_lshrrev_b32 v31, v31, s55
    v_mfma_f32_16x16x32_bf16 v[220:223], a[76:79], v[164:167], v[220:223]
    v_bfe_u32 v21, v31, 0, 1
    s_waitcnt lgkmcnt(2)
    v_mfma_f32_16x16x32_bf16 v[192:195], a[80:83], v[168:171], v[192:195]
    ds_read_b128 v[184:187], v5 offset:28672
    s_add_u32 s13, s9, s72
    v_lshlrev_b32 v11, 15, v21
    v_mfma_f32_16x16x32_bf16 v[200:203], a[84:87], v[168:171], v[200:203]
    buffer_load_dwordx4 v[60:63], v28, s[36:39], s13 offen offset:0 sc1
    v_mfma_f32_16x16x32_bf16 v[208:211], a[88:91], v[168:171], v[208:211]
    ds_read_b128 v[188:191], v6 offset:28672
    v_bfe_u32 v21, v31, 1, 1
    v_lshl_or_b32 v11, v21, 31, v11
    v_mfma_f32_16x16x32_bf16 v[216:219], a[92:95], v[168:171], v[216:219]
    s_add_u32 s18, s10, s72
    v_bfe_u32 v21, v31, 2, 1
    v_mfma_f32_16x16x32_bf16 v[196:199], a[80:83], v[172:175], v[196:199]
    buffer_load_dwordx4 v[64:67], v28, s[36:39], s18 offen offset:0 sc1
    v_mfma_f32_16x16x32_bf16 v[204:207], a[84:87], v[172:175], v[204:207]
    v_lshlrev_b32 v12, 15, v21
    v_bfe_u32 v21, v31, 3, 1
    v_mfma_f32_16x16x32_bf16 v[212:215], a[88:91], v[172:175], v[212:215]
    v_lshl_or_b32 v12, v21, 31, v12
    s_add_u32 s24, s26, 81920
    v_mfma_f32_16x16x32_bf16 v[220:223], a[92:95], v[172:175], v[220:223]
    v_add_u32 v22, s24, v3
    s_waitcnt lgkmcnt(2)
    v_mfma_f32_16x16x32_bf16 v[192:195], a[96:99], v[176:179], v[192:195]
    ds_read_b128 v[160:163], v5 offset:32768
    s_add_u32 s19, s11, s72
    v_mul_u32_u24 v29, 336, v1
    v_mfma_f32_16x16x32_bf16 v[200:203], a[100:103], v[176:179], v[200:203]
    buffer_load_dwordx4 v[68:71], v28, s[36:39], s19 offen offset:0 sc1
    v_mfma_f32_16x16x32_bf16 v[208:211], a[104:107], v[176:179], v[208:211]
    ds_read_b128 v[164:167], v6 offset:32768
    v_lshl_add_u32 v29, v2, 4, v29
    s_mul_i32 s24, s3, 10752
    v_mfma_f32_16x16x32_bf16 v[216:219], a[108:111], v[176:179], v[216:219]
    s_mul_i32 s25, s51, 5376
    s_add_u32 s24, s24, 46336
    v_mfma_f32_16x16x32_bf16 v[196:199], a[96:99], v[180:183], v[196:199]
    s_sub_u32 s24, s24, s25
    v_add_u32 v30, s24, v29
    v_mfma_f32_16x16x32_bf16 v[204:207], a[100:103], v[180:183], v[204:207]
    buffer_load_dwordx4 v[140:143], v3, s[60:63], s40 offen offset:0 sc1
    v_mfma_f32_16x16x32_bf16 v[212:215], a[104:107], v[180:183], v[212:215]
    s_lshl_b32 s25, s25, 1
    s_sub_u32 s25, s25, 5376
    v_mfma_f32_16x16x32_bf16 v[220:223], a[108:111], v[180:183], v[220:223]
    v_add_u32 v29, s25, v30
    s_waitcnt lgkmcnt(2)
    v_mfma_f32_16x16x32_bf16 v[192:195], a[112:115], v[184:187], v[192:195]
    ds_read_b128 v[168:171], v5 offset:36864
    buffer_load_dwordx4 v[144:147], v3, s[60:63], s40 offen offset:1024 sc1
    v_mfma_f32_16x16x32_bf16 v[200:203], a[116:119], v[184:187], v[200:203]
    v_lshlrev_b32 v128, 6, v0
    ds_read_b128 v[112:115], v128 offset:22016
    v_mfma_f32_16x16x32_bf16 v[208:211], a[120:123], v[184:187], v[208:211]
    ds_read_b128 v[172:175], v6 offset:36864
    ds_read_b128 v[116:119], v128 offset:22032
    v_mfma_f32_16x16x32_bf16 v[216:219], a[124:127], v[184:187], v[216:219]
    ds_read_b128 v[120:123], v128 offset:22048
    v_mfma_f32_16x16x32_bf16 v[196:199], a[112:115], v[188:191], v[196:199]
    buffer_load_dwordx4 v[148:151], v3, s[60:63], s40 offen offset:2048 sc1
    ds_read_b128 v[124:127], v128 offset:22064
    v_mfma_f32_16x16x32_bf16 v[204:207], a[116:119], v[188:191], v[204:207]
    v_mfma_f32_16x16x32_bf16 v[212:215], a[120:123], v[188:191], v[212:215]
    v_mfma_f32_16x16x32_bf16 v[220:223], a[124:127], v[188:191], v[220:223]
    s_waitcnt lgkmcnt(6)
    v_mfma_f32_16x16x32_bf16 v[192:195], a[128:131], v[160:163], v[192:195]
    ds_read_b128 v[176:179], v7 offset:0
    buffer_load_dwordx4 v[152:155], v3, s[60:63], s40 offen offset:3072 sc1
    v_mfma_f32_16x16x32_bf16 v[200:203], a[132:135], v[160:163], v[200:203]
    s_waitcnt lgkmcnt(1)
    v_mfma_f32_16x16x32_bf16 v[208:211], a[136:139], v[160:163], v[208:211]
    ds_read_b128 v[180:183], v8 offset:0
    v_add_f32 v112, v112, v120
    v_add_f32 v113, v113, v121
    v_mfma_f32_16x16x32_bf16 v[216:219], a[140:143], v[160:163], v[216:219]
    v_add_f32 v114, v114, v122
    v_add_f32 v115, v115, v123
    v_mfma_f32_16x16x32_bf16 v[196:199], a[128:131], v[164:167], v[196:199]
    buffer_load_dwordx4 v[156:159], v4, s[60:63], s40 offen offset:0 sc1
    v_mfma_f32_16x16x32_bf16 v[204:207], a[132:135], v[164:167], v[204:207]
    v_add_f32 v116, v116, v124
    v_add_f32 v117, v117, v125
    v_mfma_f32_16x16x32_bf16 v[212:215], a[136:139], v[164:167], v[212:215]
    v_add_f32 v118, v118, v126
    v_add_f32 v119, v119, v127
    v_mfma_f32_16x16x32_bf16 v[220:223], a[140:143], v[164:167], v[220:223]
    v_add_f32 v112, v112, v116
    v_mfma_f32_16x16x32_bf16 v[192:195], a[144:147], v[168:171], v[192:195]
    ds_read_b128 v[184:187], v7 offset:4096
    s_add_u32 m0, s26, 81920
    v_add_f32 v113, v113, v117
    v_mfma_f32_16x16x32_bf16 v[200:203], a[148:151], v[168:171], v[200:203]
    buffer_load_dwordx4 v3, s[60:63], s4 offen offset:0 sc1 lds
    v_mfma_f32_16x16x32_bf16 v[208:211], a[152:155], v[168:171], v[208:211]
    ds_read_b128 v[188:191], v8 offset:4096
    v_add_f32 v114, v114, v118
    v_add_f32 v115, v115, v119
    v_mfma_f32_16x16x32_bf16 v[216:219], a[156:159], v[168:171], v[216:219]
    s_add_u32 m0, s26, 81920
    v_add_f32 v112, v112, v114
    v_mfma_f32_16x16x32_bf16 v[196:199], a[144:147], v[172:175], v[196:199]
    buffer_load_dwordx4 v3, s[60:63], s4 offen offset:1024 sc1 lds
    v_mfma_f32_16x16x32_bf16 v[204:207], a[148:151], v[172:175], v[204:207]
    v_add_f32 v113, v113, v115
    v_mul_f32 v112, 0xbacccccd, v112
    v_mfma_f32_16x16x32_bf16 v[212:215], a[152:155], v[172:175], v[212:215]
    v_mul_f32 v113, 0x3acccccd, v113
    v_fma_f32 v113, -v112, v112, v113
    v_mfma_f32_16x16x32_bf16 v[220:223], a[156:159], v[172:175], v[220:223]
    v_max_f32 v113, 0, v113
    s_waitcnt lgkmcnt(2)
    v_mfma_f32_16x16x32_bf16 v[192:195], a[160:163], v[176:179], v[192:195]
    ds_read_b128 v[160:163], v7 offset:8192
    s_add_u32 m0, s26, 81920
    v_add_f32 v113, 0x3727c5ac, v113
    v_mfma_f32_16x16x32_bf16 v[200:203], a[164:167], v[176:179], v[200:203]
    buffer_load_dwordx4 v3, s[60:63], s4 offen offset:2048 sc1 lds
    v_mfma_f32_16x16x32_bf16 v[208:211], a[168:171], v[176:179], v[208:211]
    ds_read_b128 v[164:167], v8 offset:8192
    v_sqrt_f32 v114, v113
    v_mfma_f32_16x16x32_bf16 v[196:199], a[160:163], v[180:183], v[196:199]
    s_add_u32 m0, s26, 81920
    v_mfma_f32_16x16x32_bf16 v[204:207], a[164:167], v[180:183], v[204:207]
    buffer_load_dwordx4 v3, s[60:63], s4 offen offset:3072 sc1 lds
    v_mfma_f32_16x16x32_bf16 v[212:215], a[168:171], v[180:183], v[212:215]
    s_waitcnt vmcnt(39) lgkmcnt(2)
    v_mfma_f32_16x16x32_bf16 v[192:195], a[172:175], v[184:187], v[192:195]
    ds_read_b128 v[168:171], v7 offset:12288
    v_rcp_f32 v115, v113
    v_mfma_f32_16x16x32_bf16 v[200:203], a[176:179], v[184:187], v[200:203]
    s_add_u32 m0, s26, 86016
    v_cvt_pk_bf16_f32 v121, v112, v114
    v_mfma_f32_16x16x32_bf16 v[208:211], a[180:183], v[184:187], v[208:211]
    ds_read_b128 v[172:175], v8 offset:12288
    buffer_load_dwordx4 v4, s[60:63], s4 offen offset:0 sc1 lds
    v_mfma_f32_16x16x32_bf16 v[196:199], a[172:175], v[188:191], v[196:199]
    v_lshlrev_b32 v117, 16, v121
    v_and_b32 v118, 0xffff0000, v121
    v_mfma_f32_16x16x32_bf16 v[204:207], a[176:179], v[188:191], v[204:207]
    ds_write_b128 v19, v[220:223] offset:0
    v_mfma_f32_16x16x32_bf16 v[212:215], a[180:183], v[188:191], v[212:215]
    v_sub_f32 v117, v112, v117
    s_waitcnt vmcnt(37) lgkmcnt(3)
    v_mfma_f32_16x16x32_bf16 v[192:195], a[184:187], v[160:163], v[192:195]
    ds_read_b128 v[176:179], v7 offset:16384
    s_add_u32 m0, s26, 87040
    v_sub_f32 v118, v114, v118
    v_mfma_f32_16x16x32_bf16 v[200:203], a[188:191], v[160:163], v[200:203]
    buffer_load_dwordx4 v3, s[60:63], s5 offen offset:0 sc1 lds
    v_mfma_f32_16x16x32_bf16 v[208:211], a[192:195], v[160:163], v[208:211]
    ds_read_b128 v[180:183], v8 offset:16384
    v_cvt_pk_bf16_f32 v120, v112, v117
    v_mov_b32 v123, 0
    v_mfma_f32_16x16x32_bf16 v[196:199], a[184:187], v[164:167], v[196:199]
    s_add_u32 m0, s26, 87040
    v_cvt_pk_bf16_f32 v122, v118, v123
    v_mfma_f32_16x16x32_bf16 v[204:207], a[188:191], v[164:167], v[204:207]
    buffer_load_dwordx4 v3, s[60:63], s5 offen offset:1024 sc1 lds
    v_mfma_f32_16x16x32_bf16 v[212:215], a[192:195], v[164:167], v[212:215]
    v_lshlrev_b32 v118, 2, v0
    s_waitcnt vmcnt(36) lgkmcnt(3)
    v_mfma_f32_16x16x32_bf16 v[192:195], a[196:199], v[168:171], v[192:195]
    ds_read_b128 v[184:187], v7 offset:20480
    ds_write_b128 v3, v[120:123] offset:20480
    v_mfma_f32_16x16x32_bf16 v[200:203], a[200:203], v[168:171], v[200:203]
    s_add_u32 m0, s26, 87040
    v_mfma_f32_16x16x32_bf16 v[208:211], a[204:207], v[168:171], v[208:211]
    ds_read_b128 v[188:191], v8 offset:20480
    buffer_load_dwordx4 v3, s[60:63], s5 offen offset:2048 sc1 lds
    v_mfma_f32_16x16x32_bf16 v[196:199], a[196:199], v[172:175], v[196:199]
    ds_write_b32 v118, v115 offset:21504
    v_mfma_f32_16x16x32_bf16 v[204:207], a[200:203], v[172:175], v[204:207]
    s_add_u32 m0, s26, 87040
    v_mfma_f32_16x16x32_bf16 v[212:215], a[204:207], v[172:175], v[212:215]
    v_lshlrev_b32 v132, 2, v27
    ds_read_b32 v16, v132 offset:21504
    s_waitcnt vmcnt(34) lgkmcnt(5)
    v_mfma_f32_16x16x32_bf16 v[192:195], a[208:211], v[176:179], v[192:195]
    ds_read_b128 v[160:163], v7 offset:24576
    buffer_load_dwordx4 v3, s[60:63], s5 offen offset:3072 sc1 lds
    ds_read_b32 v17, v132 offset:21632
    v_mfma_f32_16x16x32_bf16 v[200:203], a[212:215], v[176:179], v[200:203]
    v_lshrrev_b32 v133, 1, v27
    v_and_b32 v133, 6, v133
    v_mfma_f32_16x16x32_bf16 v[208:211], a[216:219], v[176:179], v[208:211]
    ds_read_b128 v[164:167], v8 offset:24576
    s_add_u32 m0, s26, 91136
    s_movk_i32 s24, 0x78
    v_mfma_f32_16x16x32_bf16 v[196:199], a[208:211], v[180:183], v[196:199]
    v_bfe_u32 v133, s24, v133, 2
    s_mov_b32 s24, 122880
    v_mfma_f32_16x16x32_bf16 v[204:207], a[212:215], v[180:183], v[204:207]
    s_mov_b32 s44, 0x05040c0c
    s_mov_b32 s45, 0x03020c0c
    v_mfma_f32_16x16x32_bf16 v[212:215], a[216:219], v[180:183], v[212:215]
    s_cmp_ge_u32 s49, 4
    s_cselect_b32 s24, 0, s24
    s_cselect_b32 s44, s45, s44
    s_cselect_b32 s45, 0x01000c0c, s45
    v_lshl_add_u32 v132, v27, 6, s24
    s_waitcnt vmcnt(32) lgkmcnt(5)
    v_mfma_f32_16x16x32_bf16 v[192:195], a[220:223], v[184:187], v[192:195]
    ds_read_b128 v[168:171], v7 offset:28672
    buffer_load_dwordx4 v4, s[60:63], s5 offen offset:0 sc1 lds
    v_mfma_f32_16x16x32_bf16 v[200:203], a[224:227], v[184:187], v[200:203]
    s_mul_i32 s24, s49, 10
    v_add_u32 v134, s24, v25
    v_mfma_f32_16x16x32_bf16 v[208:211], a[228:231], v[184:187], v[208:211]
    ds_read_b128 v[172:175], v8 offset:28672
    s_add_u32 m0, s53, 8192
    v_mov_b32 v136, v134
    v_mfma_f32_16x16x32_bf16 v[196:199], a[220:223], v[188:191], v[196:199]
    buffer_load_dwordx4 v3, s[60:63], s15 offen offset:0 sc1 lds
    v_mfma_f32_16x16x32_bf16 v[204:207], a[224:227], v[188:191], v[204:207]
    s_barrier
    ds_read_b128 v[220:223], v20 offset:0
    v_mfma_f32_16x16x32_bf16 v[212:215], a[228:231], v[188:191], v[212:215]
    v_and_b32 v135, 3, v136
    s_waitcnt vmcnt(31) lgkmcnt(3)
    v_mfma_f32_16x16x32_bf16 v[192:195], a[232:235], v[160:163], v[192:195]
    ds_read_b128 v[176:179], v7 offset:32768
    s_add_u32 m0, s53, 11264
    v_lshrrev_b32 v136, 2, v136
    v_mfma_f32_16x16x32_bf16 v[200:203], a[236:239], v[160:163], v[200:203]
    buffer_load_dwordx4 v3, s[60:63], s15 offen offset:1024 sc1 lds
    v_mfma_f32_16x16x32_bf16 v[208:211], a[240:243], v[160:163], v[208:211]
    ds_read_b128 v[180:183], v8 offset:32768
    v_xor_b32 v135, v135, v133
    v_lshl_add_u32 v136, v136, 12, v132
    v_mfma_f32_16x16x32_bf16 v[196:199], a[232:235], v[164:167], v[196:199]
    v_lshl_add_u32 v136, v135, 4, v136
    v_add_u32 v137, 5, v134
    v_mfma_f32_16x16x32_bf16 v[204:207], a[236:239], v[164:167], v[204:207]
    s_add_u32 m0, s53, 14336
    v_and_b32 v135, 3, v137
    v_mfma_f32_16x16x32_bf16 v[212:215], a[240:243], v[164:167], v[212:215]
    v_lshrrev_b32 v137, 2, v137
    s_waitcnt vmcnt(28) lgkmcnt(3)
    v_mfma_f32_16x16x32_bf16 v[192:195], a[244:247], v[168:171], v[192:195]
    ds_read_b128 v[184:187], v7 offset:36864
    buffer_load_dwordx4 v3, s[60:63], s15 offen offset:2048 sc1 lds
    v_mfma_f32_16x16x32_bf16 v[200:203], a[248:251], v[168:171], v[200:203]
    v_xor_b32 v135, v135, v133
    v_lshl_add_u32 v137, v137, 12, v132
    v_mfma_f32_16x16x32_bf16 v[208:211], a[252:255], v[168:171], v[208:211]
    ds_read_b128 v[188:191], v8 offset:36864
    s_add_u32 m0, s53, 23040
    v_lshl_add_u32 v137, v135, 4, v137
    v_mfma_f32_16x16x32_bf16 v[196:199], a[244:247], v[172:175], v[196:199]
    buffer_load_dwordx4 v3, s[60:63], s15 offen offset:3072 sc1 lds
    v_mfma_f32_16x16x32_bf16 v[204:207], a[248:251], v[172:175], v[204:207]
    v_max_u32 v138, 1, v134
    v_subrev_u32 v138, 1, v138
    v_mfma_f32_16x16x32_bf16 v[212:215], a[252:255], v[172:175], v[212:215]
    v_mov_b32 v135, 79
    s_waitcnt vmcnt(26) lgkmcnt(2)
    v_mfma_f32_16x16x32_bf16 v[192:195], v[32:35], v[176:179], v[192:195]
    ds_read_b128 v[160:163], v9 offset:20480
    s_add_u32 m0, s53, 30208
    v_cmp_eq_u32 vcc, 40, v134
    v_mfma_f32_16x16x32_bf16 v[200:203], v[36:39], v[176:179], v[200:203]
    s_nop 0
    v_cndmask_b32 v138, v138, v135, vcc
    v_and_b32 v135, 3, v138
    v_mfma_f32_16x16x32_bf16 v[208:211], v[40:43], v[176:179], v[208:211]
    ds_read_b128 v[164:167], v10 offset:20480
    buffer_load_dwordx4 v4, s[60:63], s15 offen offset:0 sc1 lds
    v_mfma_f32_16x16x32_bf16 v[196:199], v[32:35], v[180:183], v[196:199]
    v_lshrrev_b32 v138, 2, v138
    v_xor_b32 v135, v135, v133
    v_mfma_f32_16x16x32_bf16 v[204:207], v[36:39], v[180:183], v[204:207]
    s_add_u32 m0, s53, 34304
    v_lshl_add_u32 v138, v138, 12, v132
    v_mfma_f32_16x16x32_bf16 v[212:215], v[40:43], v[180:183], v[212:215]
    v_lshl_add_u32 v138, v135, 4, v138
    s_waitcnt vmcnt(24) lgkmcnt(2)
    v_mfma_f32_16x16x32_bf16 v[192:195], v[44:47], v[184:187], v[192:195]
    ds_read_b128 v[168:171], v5 offset:2048
    buffer_load_dwordx4 v3, s[60:63], s16 offen offset:0 sc1 lds
    v_mfma_f32_16x16x32_bf16 v[200:203], v[48:51], v[184:187], v[200:203]
    v_add_u32 v139, 4, v134
    v_and_b32 v135, 3, v139
    v_mfma_f32_16x16x32_bf16 v[208:211], v[52:55], v[184:187], v[208:211]
    ds_read_b128 v[172:175], v6 offset:2048
    v_lshrrev_b32 v139, 2, v139
    v_xor_b32 v135, v135, v133
    v_mfma_f32_16x16x32_bf16 v[196:199], v[44:47], v[188:191], v[196:199]
    v_lshl_add_u32 v139, v139, 12, v132
    v_lshl_add_u32 v139, v135, 4, v139
    ds_read_b128 v[116:119], v136 offset:0
    v_mfma_f32_16x16x32_bf16 v[204:207], v[48:51], v[188:191], v[204:207]
    ds_read_b32 v112, v138 offset:12
    v_mfma_f32_16x16x32_bf16 v[212:215], v[52:55], v[188:191], v[212:215]
    ds_read_b128 v[120:123], v137 offset:0
    s_waitcnt vmcnt(21) lgkmcnt(5)
    v_mfma_f32_16x16x32_bf16 v[192:195], v[56:59], v[160:163], v[192:195]
    ds_read_b128 v[176:179], v5 offset:6144
    ds_read_b32 v113, v139 offset:12
    v_mfma_f32_16x16x32_bf16 v[200:203], v[60:63], v[160:163], v[200:203]
    ds_read_b128 v[124:127], v136 offset:2048
    v_mfma_f32_16x16x32_bf16 v[208:211], v[64:67], v[160:163], v[208:211]
    ds_read_b128 v[180:183], v6 offset:6144
    ds_read_b32 v114, v138 offset:2060
    v_mfma_f32_16x16x32_bf16 v[220:223], v[68:71], v[160:163], v[220:223]
    ds_read_b128 v[128:131], v137 offset:2048
    v_mfma_f32_16x16x32_bf16 v[196:199], v[56:59], v[164:167], v[196:199]
    ds_read_b32 v115, v139 offset:2060
    v_mfma_f32_16x16x32_bf16 v[204:207], v[60:63], v[164:167], v[204:207]
    v_lshlrev_b32 v88, 16, v104
    v_and_b32 v89, 0xffff0000, v104
    v_mfma_f32_16x16x32_bf16 v[212:215], v[64:67], v[164:167], v[212:215]
    v_lshlrev_b32 v90, 16, v105
    s_waitcnt lgkmcnt(10)
    v_mfma_f32_16x16x32_bf16 v[224:227], a[0:3], v[168:171], 0
    ds_read_b128 v[184:187], v5 offset:10240
    v_and_b32 v91, 0xffff0000, v105
    v_lshlrev_b32 v92, 16, v106
    v_mfma_f32_16x16x32_bf16 v[232:235], a[4:7], v[168:171], 0
    v_and_b32 v93, 0xffff0000, v106
    v_lshlrev_b32 v94, 16, v107
    v_mfma_f32_16x16x32_bf16 v[240:243], a[8:11], v[168:171], 0
    ds_read_b128 v[188:191], v6 offset:10240
    v_and_b32 v95, 0xffff0000, v107
    v_lshlrev_b32 v96, 16, v108
    v_mfma_f32_16x16x32_bf16 v[248:251], a[12:15], v[168:171], 0
    v_and_b32 v97, 0xffff0000, v108
    v_lshlrev_b32 v98, 16, v109
    v_mfma_f32_16x16x32_bf16 v[228:231], a[0:3], v[172:175], 0
    buffer_load_dwordx4 a[0:3], v3, s[60:63], s16 offen offset:1024 sc1
    v_mfma_f32_16x16x32_bf16 v[236:239], a[4:7], v[172:175], 0
    v_and_b32 v99, 0xffff0000, v109
    v_lshlrev_b32 v100, 16, v110
    v_mfma_f32_16x16x32_bf16 v[244:247], a[8:11], v[172:175], 0
    v_and_b32 v101, 0xffff0000, v110
    v_lshlrev_b32 v102, 16, v111
    v_mfma_f32_16x16x32_bf16 v[252:255], a[12:15], v[172:175], 0
    v_and_b32 v103, 0xffff0000, v111
    s_waitcnt lgkmcnt(5)
    v_mfma_f32_16x16x32_bf16 v[224:227], a[16:19], v[176:179], v[224:227]
    ds_read_b128 v[160:163], v5 offset:14336
    buffer_load_dwordx4 a[4:7], v3, s[60:63], s16 offen offset:2048 sc1
    v_mfma_f32_16x16x32_bf16 v[232:235], a[20:23], v[176:179], v[232:235]
    v_max_f32 v192, 0, v192
    v_max_f32 v193, 0, v193
    v_mfma_f32_16x16x32_bf16 v[240:243], a[24:27], v[176:179], v[240:243]
    ds_read_b128 v[164:167], v6 offset:14336
    v_max_f32 v194, 0, v194
    v_max_f32 v195, 0, v195
    v_mfma_f32_16x16x32_bf16 v[248:251], a[28:31], v[176:179], v[248:251]
    buffer_load_dwordx4 a[8:11], v3, s[60:63], s16 offen offset:3072 sc1
    v_mfma_f32_16x16x32_bf16 v[228:231], a[16:19], v[180:183], v[228:231]
    v_mul_f32 v192, v192, v192
    v_mul_f32 v193, v193, v193
    v_mfma_f32_16x16x32_bf16 v[236:239], a[20:23], v[180:183], v[236:239]
    v_mul_f32 v194, v194, v194
    v_mul_f32 v195, v195, v195
    v_mfma_f32_16x16x32_bf16 v[244:247], a[24:27], v[180:183], v[244:247]
    v_cvt_pk_bf16_f32 v192, v192, v193
    v_cvt_pk_bf16_f32 v193, v194, v195
    v_mfma_f32_16x16x32_bf16 v[252:255], a[28:31], v[180:183], v[252:255]
    v_max_f32 v200, 0, v200
    s_waitcnt lgkmcnt(2)
    v_mfma_f32_16x16x32_bf16 v[224:227], a[32:35], v[184:187], v[224:227]
    ds_read_b128 v[168:171], v5 offset:18432
    buffer_load_dwordx4 a[12:15], v4, s[60:63], s16 offen offset:0 sc1
    v_mfma_f32_16x16x32_bf16 v[232:235], a[36:39], v[184:187], v[232:235]
    v_max_f32 v201, 0, v201
    v_max_f32 v202, 0, v202
    v_mfma_f32_16x16x32_bf16 v[240:243], a[40:43], v[184:187], v[240:243]
    ds_read_b128 v[172:175], v6 offset:18432
    v_max_f32 v203, 0, v203
    v_mul_f32 v200, v200, v200
    v_mfma_f32_16x16x32_bf16 v[248:251], a[44:47], v[184:187], v[248:251]
    buffer_load_dwordx4 a[16:19], v3, s[60:63], s17 offen offset:0 sc1
    v_mfma_f32_16x16x32_bf16 v[228:231], a[32:35], v[188:191], v[228:231]
    v_mul_f32 v201, v201, v201
    v_mul_f32 v202, v202, v202
    v_mfma_f32_16x16x32_bf16 v[236:239], a[36:39], v[188:191], v[236:239]
    v_mul_f32 v203, v203, v203
    v_cvt_pk_bf16_f32 v194, v200, v201
    v_mfma_f32_16x16x32_bf16 v[244:247], a[40:43], v[188:191], v[244:247]
    v_cvt_pk_bf16_f32 v195, v202, v203
    v_or_b32 v192, v11, v192
    v_mfma_f32_16x16x32_bf16 v[252:255], a[44:47], v[188:191], v[252:255]
    v_or_b32 v195, v12, v195
    s_waitcnt lgkmcnt(2)
    v_mfma_f32_16x16x32_bf16 v[224:227], a[48:51], v[160:163], v[224:227]
    ds_read_b128 v[176:179], v5 offset:22528
    buffer_load_dwordx4 a[20:23], v3, s[60:63], s17 offen offset:1024 sc1
    v_mfma_f32_16x16x32_bf16 v[232:235], a[52:55], v[160:163], v[232:235]
    buffer_store_dwordx4 v[192:195], v13, s[64:67], s40 offen offset:0 sc1
    v_mfma_f32_16x16x32_bf16 v[240:243], a[56:59], v[160:163], v[240:243]
    ds_read_b128 v[180:183], v6 offset:22528
    v_max_f32 v196, 0, v196
    v_max_f32 v197, 0, v197
    v_mfma_f32_16x16x32_bf16 v[248:251], a[60:63], v[160:163], v[248:251]
    v_max_f32 v198, 0, v198
    v_max_f32 v199, 0, v199
    v_mfma_f32_16x16x32_bf16 v[228:231], a[48:51], v[164:167], v[228:231]
    v_mul_f32 v196, v196, v196
    v_mul_f32 v197, v197, v197
    v_mfma_f32_16x16x32_bf16 v[236:239], a[52:55], v[164:167], v[236:239]
    v_mul_f32 v198, v198, v198
    v_mul_f32 v199, v199, v199
    v_mfma_f32_16x16x32_bf16 v[244:247], a[56:59], v[164:167], v[244:247]
    v_cvt_pk_bf16_f32 v196, v196, v197
    v_cvt_pk_bf16_f32 v197, v198, v199
    v_mfma_f32_16x16x32_bf16 v[252:255], a[60:63], v[164:167], v[252:255]
    v_max_f32 v204, 0, v204
    s_waitcnt lgkmcnt(2)
    v_mfma_f32_16x16x32_bf16 v[224:227], a[64:67], v[168:171], v[224:227]
    ds_read_b128 v[184:187], v5 offset:26624
    buffer_load_dwordx4 a[24:27], v3, s[60:63], s17 offen offset:2048 sc1
    v_mfma_f32_16x16x32_bf16 v[232:235], a[68:71], v[168:171], v[232:235]
    v_max_f32 v205, 0, v205
    v_max_f32 v206, 0, v206
    v_mfma_f32_16x16x32_bf16 v[240:243], a[72:75], v[168:171], v[240:243]
    ds_read_b128 v[188:191], v6 offset:26624
    v_max_f32 v207, 0, v207
    v_mul_f32 v204, v204, v204
    v_mfma_f32_16x16x32_bf16 v[248:251], a[76:79], v[168:171], v[248:251]
    buffer_load_dwordx4 a[28:31], v3, s[60:63], s17 offen offset:3072 sc1
    v_mfma_f32_16x16x32_bf16 v[228:231], a[64:67], v[172:175], v[228:231]
    v_mul_f32 v205, v205, v205
    v_mul_f32 v206, v206, v206
    v_mfma_f32_16x16x32_bf16 v[236:239], a[68:71], v[172:175], v[236:239]
    v_mul_f32 v207, v207, v207
    v_cvt_pk_bf16_f32 v198, v204, v205
    v_mfma_f32_16x16x32_bf16 v[244:247], a[72:75], v[172:175], v[244:247]
    v_cvt_pk_bf16_f32 v199, v206, v207
    v_or_b32 v196, v11, v196
    v_mfma_f32_16x16x32_bf16 v[252:255], a[76:79], v[172:175], v[252:255]
    v_or_b32 v199, v12, v199
    s_waitcnt lgkmcnt(2)
    v_mfma_f32_16x16x32_bf16 v[224:227], a[80:83], v[176:179], v[224:227]
    ds_read_b128 v[160:163], v5 offset:30720
    buffer_load_dwordx4 a[32:35], v4, s[60:63], s17 offen offset:0 sc1
    v_mfma_f32_16x16x32_bf16 v[232:235], a[84:87], v[176:179], v[232:235]
    buffer_store_dwordx4 v[196:199], v14, s[64:67], s40 offen offset:0 sc1
    v_mfma_f32_16x16x32_bf16 v[240:243], a[88:91], v[176:179], v[240:243]
    ds_read_b128 v[164:167], v6 offset:30720
    v_max_f32 v208, 0, v208
    v_max_f32 v209, 0, v209
    v_mfma_f32_16x16x32_bf16 v[248:251], a[92:95], v[176:179], v[248:251]
    v_max_f32 v210, 0, v210
    v_max_f32 v211, 0, v211
    v_mfma_f32_16x16x32_bf16 v[228:231], a[80:83], v[180:183], v[228:231]
    v_mul_f32 v208, v208, v208
    v_mul_f32 v209, v209, v209
    v_mfma_f32_16x16x32_bf16 v[236:239], a[84:87], v[180:183], v[236:239]
    v_mul_f32 v210, v210, v210
    v_mul_f32 v211, v211, v211
    v_mfma_f32_16x16x32_bf16 v[244:247], a[88:91], v[180:183], v[244:247]
    v_cvt_pk_bf16_f32 v208, v208, v209
    v_cvt_pk_bf16_f32 v209, v210, v211
    v_mfma_f32_16x16x32_bf16 v[252:255], a[92:95], v[180:183], v[252:255]
    v_max_f32 v212, 0, v212
    s_waitcnt lgkmcnt(2)
    v_mfma_f32_16x16x32_bf16 v[224:227], a[96:99], v[184:187], v[224:227]
    ds_read_b128 v[168:171], v5 offset:34816
    buffer_load_dwordx4 a[36:39], v3, s[60:63], s43 offen offset:0 sc1
    v_mfma_f32_16x16x32_bf16 v[232:235], a[100:103], v[184:187], v[232:235]
    v_max_f32 v213, 0, v213
    v_max_f32 v214, 0, v214
    v_mfma_f32_16x16x32_bf16 v[240:243], a[104:107], v[184:187], v[240:243]
    ds_read_b128 v[172:175], v6 offset:34816
    v_max_f32 v215, 0, v215
    v_mul_f32 v212, v212, v212
    v_mfma_f32_16x16x32_bf16 v[248:251], a[108:111], v[184:187], v[248:251]
    buffer_load_dwordx4 a[40:43], v3, s[60:63], s43 offen offset:1024 sc1
    v_mfma_f32_16x16x32_bf16 v[228:231], a[96:99], v[188:191], v[228:231]
    v_mul_f32 v213, v213, v213
    v_mul_f32 v214, v214, v214
    v_mfma_f32_16x16x32_bf16 v[236:239], a[100:103], v[188:191], v[236:239]
    v_mul_f32 v215, v215, v215
    v_cvt_pk_bf16_f32 v210, v212, v213
    v_mfma_f32_16x16x32_bf16 v[244:247], a[104:107], v[188:191], v[244:247]
    v_cvt_pk_bf16_f32 v211, v214, v215
    v_mfma_f32_16x16x32_bf16 v[252:255], a[108:111], v[188:191], v[252:255]
    v_permlane32_swap_b32 v208, v210
    s_waitcnt lgkmcnt(2)
    v_mfma_f32_16x16x32_bf16 v[224:227], a[112:115], v[160:163], v[224:227]
    ds_read_b128 v[176:179], v5 offset:38912
    buffer_load_dwordx4 a[44:47], v3, s[60:63], s43 offen offset:2048 sc1
    v_mfma_f32_16x16x32_bf16 v[232:235], a[116:119], v[160:163], v[232:235]
    v_permlane32_swap_b32 v209, v211
    v_or_b32 v208, v11, v208
    v_mfma_f32_16x16x32_bf16 v[240:243], a[120:123], v[160:163], v[240:243]
    ds_read_b128 v[180:183], v6 offset:38912
    v_or_b32 v211, v12, v211
    v_mfma_f32_16x16x32_bf16 v[248:251], a[124:127], v[160:163], v[248:251]
    buffer_load_dwordx4 a[48:51], v3, s[60:63], s43 offen offset:3072 sc1
    v_mfma_f32_16x16x32_bf16 v[228:231], a[112:115], v[164:167], v[228:231]
    buffer_store_dwordx4 v[208:211], v15, s[64:67], s41 offen offset:0 sc1
    v_mfma_f32_16x16x32_bf16 v[236:239], a[116:119], v[164:167], v[236:239]
    v_add_f32 v216, v216, v220
    v_add_f32 v217, v217, v221
    v_mfma_f32_16x16x32_bf16 v[244:247], a[120:123], v[164:167], v[244:247]
    v_add_f32 v218, v218, v222
    v_add_f32 v219, v219, v223
    v_mfma_f32_16x16x32_bf16 v[252:255], a[124:127], v[164:167], v[252:255]
    v_max_f32 v216, 0, v216
    s_waitcnt lgkmcnt(2)
    v_mfma_f32_16x16x32_bf16 v[224:227], a[128:131], v[168:171], v[224:227]
    ds_read_b128 v[184:187], v7 offset:2048
    s_waitcnt vmcnt(16)
    ds_read_b128 a[52:55], v22 offset:0
    v_mfma_f32_16x16x32_bf16 v[232:235], a[132:135], v[168:171], v[232:235]
    ds_read_b128 a[56:59], v22 offset:1024
    v_mfma_f32_16x16x32_bf16 v[240:243], a[136:139], v[168:171], v[240:243]
    ds_read_b128 v[188:191], v8 offset:2048
    ds_read_b128 a[60:63], v22 offset:2048
    v_mfma_f32_16x16x32_bf16 v[248:251], a[140:143], v[168:171], v[248:251]
    buffer_load_dwordx4 a[64:67], v4, s[60:63], s43 offen offset:0 sc1
    v_mfma_f32_16x16x32_bf16 v[228:231], a[128:131], v[172:175], v[228:231]
    ds_read_b128 a[68:71], v22 offset:3072
    v_mfma_f32_16x16x32_bf16 v[236:239], a[132:135], v[172:175], v[236:239]
    ds_read_b128 a[72:75], v22 offset:4096
    v_mfma_f32_16x16x32_bf16 v[244:247], a[136:139], v[172:175], v[244:247]
    ds_read_b128 a[76:79], v22 offset:5120
    v_mfma_f32_16x16x32_bf16 v[252:255], a[140:143], v[172:175], v[252:255]
    ds_read_b128 a[80:83], v22 offset:6144
    s_waitcnt lgkmcnt(9)
    v_mfma_f32_16x16x32_bf16 v[224:227], a[144:147], v[176:179], v[224:227]
    ds_read_b128 v[160:163], v7 offset:6144
    buffer_load_dwordx4 a[84:87], v3, s[60:63], s56 offen offset:0 sc1
    v_mfma_f32_16x16x32_bf16 v[232:235], a[148:151], v[176:179], v[232:235]
    ds_read_b128 a[88:91], v22 offset:7168
    v_mfma_f32_16x16x32_bf16 v[240:243], a[152:155], v[176:179], v[240:243]
    ds_read_b128 v[164:167], v8 offset:6144
    ds_read_b128 a[92:95], v22 offset:8192
    v_mfma_f32_16x16x32_bf16 v[248:251], a[156:159], v[176:179], v[248:251]
    buffer_load_dwordx4 a[96:99], v3, s[60:63], s56 offen offset:1024 sc1
    v_mfma_f32_16x16x32_bf16 v[228:231], a[144:147], v[180:183], v[228:231]
    ds_read_b128 a[100:103], v22 offset:9216
    v_mfma_f32_16x16x32_bf16 v[236:239], a[148:151], v[180:183], v[236:239]
    ds_read_b128 a[104:107], v19 offset:8192
    v_mfma_f32_16x16x32_bf16 v[244:247], a[152:155], v[180:183], v[244:247]
    ds_read_b128 a[108:111], v19 offset:12288
    v_mfma_f32_16x16x32_bf16 v[252:255], a[156:159], v[180:183], v[252:255]
    s_waitcnt lgkmcnt(12)
    v_mfma_f32_16x16x32_bf16 v[224:227], a[160:163], v[184:187], v[224:227]
    ds_read_b128 v[168:171], v7 offset:10240
    buffer_load_dwordx4 a[112:115], v3, s[60:63], s56 offen offset:2048 sc1
    v_mfma_f32_16x16x32_bf16 v[232:235], a[164:167], v[184:187], v[232:235]
    ds_read_b128 a[116:119], v19 offset:16384
    v_mfma_f32_16x16x32_bf16 v[240:243], a[168:171], v[184:187], v[240:243]
    ds_read_b128 v[172:175], v8 offset:10240
    ds_read_b128 a[120:123], v19 offset:26112
    v_mfma_f32_16x16x32_bf16 v[228:231], a[160:163], v[188:191], v[228:231]
    buffer_load_dwordx4 a[124:127], v3, s[60:63], s56 offen offset:3072 sc1
    v_mfma_f32_16x16x32_bf16 v[236:239], a[164:167], v[188:191], v[236:239]
    ds_read_b128 a[128:131], v19 offset:30208
    v_mfma_f32_16x16x32_bf16 v[244:247], a[168:171], v[188:191], v[244:247]
    ds_read_b128 a[132:135], v19 offset:34304
    s_waitcnt lgkmcnt(10)
    v_mfma_f32_16x16x32_bf16 v[224:227], a[172:175], v[160:163], v[224:227]
    ds_read_b128 v[176:179], v7 offset:14336
    v_mfma_f32_16x16x32_bf16 v[232:235], a[176:179], v[160:163], v[232:235]
    buffer_load_dwordx4 a[136:139], v4, s[60:63], s56 offen offset:0 sc1
    v_mfma_f32_16x16x32_bf16 v[240:243], a[180:183], v[160:163], v[240:243]
    ds_read_b128 v[180:183], v8 offset:14336
    v_max_f32 v217, 0, v217
    v_max_f32 v218, 0, v218
    v_mfma_f32_16x16x32_bf16 v[228:231], a[172:175], v[164:167], v[228:231]
    v_max_f32 v219, 0, v219
    v_mul_f32 v216, v216, v216
    v_mfma_f32_16x16x32_bf16 v[236:239], a[176:179], v[164:167], v[236:239]
    ds_write_b128 v19, v[252:255] offset:4096
    v_mfma_f32_16x16x32_bf16 v[244:247], a[180:183], v[164:167], v[244:247]
    v_mul_f32 v217, v217, v217
    s_waitcnt lgkmcnt(6)
    v_mfma_f32_16x16x32_bf16 v[224:227], a[184:187], v[168:171], v[224:227]
    ds_read_b128 v[184:187], v7 offset:18432
    buffer_load_dwordx4 a[140:143], v3, s[60:63], s57 offen offset:0 sc1
    v_mfma_f32_16x16x32_bf16 v[232:235], a[188:191], v[168:171], v[232:235]
    v_mul_f32 v218, v218, v218
    v_mul_f32 v219, v219, v219
    v_mfma_f32_16x16x32_bf16 v[240:243], a[192:195], v[168:171], v[240:243]
    ds_read_b128 v[188:191], v8 offset:18432
    v_cvt_pk_bf16_f32 v216, v216, v217
    v_cvt_pk_bf16_f32 v217, v218, v219
    v_mfma_f32_16x16x32_bf16 v[228:231], a[184:187], v[172:175], v[228:231]
    buffer_load_dwordx4 a[144:147], v3, s[60:63], s57 offen offset:1024 sc1
    v_mfma_f32_16x16x32_bf16 v[236:239], a[188:191], v[172:175], v[236:239]
    v_permlane32_swap_b32 v216, v218
    v_mfma_f32_16x16x32_bf16 v[244:247], a[192:195], v[172:175], v[244:247]
    v_permlane32_swap_b32 v217, v219
    s_waitcnt lgkmcnt(3)
    v_mfma_f32_16x16x32_bf16 v[224:227], a[196:199], v[176:179], v[224:227]
    ds_read_b128 v[160:163], v7 offset:22528
    v_or_b32 v216, v11, v216
    v_or_b32 v219, v12, v219
    v_mfma_f32_16x16x32_bf16 v[232:235], a[200:203], v[176:179], v[232:235]
    buffer_load_dwordx4 a[148:151], v3, s[60:63], s57 offen offset:2048 sc1
    v_mfma_f32_16x16x32_bf16 v[240:243], a[204:207], v[176:179], v[240:243]
    ds_read_b128 v[164:167], v8 offset:22528
    buffer_store_dwordx4 v[216:219], v18, s[64:67], s42 offen offset:0 sc1
    v_mfma_f32_16x16x32_bf16 v[228:231], a[196:199], v[180:183], v[228:231]
    v_xor_b32 v192, v11, v192
    v_xor_b32 v195, v12, v195
    v_mfma_f32_16x16x32_bf16 v[236:239], a[200:203], v[180:183], v[236:239]
    v_xor_b32 v196, v11, v196
    v_xor_b32 v199, v12, v199
    v_mfma_f32_16x16x32_bf16 v[244:247], a[204:207], v[180:183], v[244:247]
    s_waitcnt lgkmcnt(2)
    v_mfma_f32_16x16x32_bf16 v[224:227], a[208:211], v[184:187], v[224:227]
    ds_read_b128 v[168:171], v7 offset:26624
    v_mfma_f32_16x16x32_bf16 v[232:235], a[212:215], v[184:187], v[232:235]
    v_perm_b32 v132, v116, v112, s44
    v_perm_b32 v133, v116, v116, s45
    v_mfma_f32_16x16x32_bf16 v[240:243], a[216:219], v[184:187], v[240:243]
    ds_read_b128 v[172:175], v8 offset:26624
    v_add_f32 v72, v132, v88
    v_add_f32 v73, v133, v89
    v_mfma_f32_16x16x32_bf16 v[228:231], a[208:211], v[188:191], v[228:231]
    buffer_load_dwordx4 a[152:155], v3, s[60:63], s57 offen offset:3072 sc1
    v_mfma_f32_16x16x32_bf16 v[236:239], a[212:215], v[188:191], v[236:239]
    v_perm_b32 v134, v117, v116, s44
    v_perm_b32 v135, v117, v117, s45
    v_mfma_f32_16x16x32_bf16 v[244:247], a[216:219], v[188:191], v[244:247]
    v_add_f32 v74, v134, v90
    s_waitcnt lgkmcnt(2)
    v_mfma_f32_16x16x32_bf16 v[224:227], a[220:223], v[160:163], v[224:227]
    ds_read_b128 v[176:179], v7 offset:30720
    v_add_f32 v75, v135, v91
    v_perm_b32 v132, v118, v117, s44
    v_mfma_f32_16x16x32_bf16 v[232:235], a[224:227], v[160:163], v[232:235]
    buffer_load_dwordx4 a[156:159], v4, s[60:63], s57 offen offset:0 sc1
    v_mfma_f32_16x16x32_bf16 v[240:243], a[228:231], v[160:163], v[240:243]
    ds_read_b128 v[180:183], v8 offset:30720
    v_perm_b32 v133, v118, v118, s45
    v_add_f32 v76, v132, v92
    v_mfma_f32_16x16x32_bf16 v[228:231], a[220:223], v[164:167], v[228:231]
    v_add_f32 v77, v133, v93
    v_perm_b32 v134, v119, v118, s44
    v_mfma_f32_16x16x32_bf16 v[236:239], a[224:227], v[164:167], v[236:239]
    s_barrier
    ds_read_b128 v[252:255], v20 offset:4096
    v_mfma_f32_16x16x32_bf16 v[244:247], a[228:231], v[164:167], v[244:247]
    v_perm_b32 v135, v119, v119, s45
    s_waitcnt lgkmcnt(3)
    v_mfma_f32_16x16x32_bf16 v[224:227], a[232:235], v[168:171], v[224:227]
    ds_read_b128 v[184:187], v7 offset:34816
    buffer_load_dwordx4 a[160:163], v3, s[60:63], s58 offen offset:0 sc1
    v_mfma_f32_16x16x32_bf16 v[232:235], a[236:239], v[168:171], v[232:235]
    v_add_f32 v78, v134, v94
    v_add_f32 v79, v135, v95
    v_mfma_f32_16x16x32_bf16 v[240:243], a[240:243], v[168:171], v[240:243]
    ds_read_b128 v[188:191], v8 offset:34816
    v_perm_b32 v132, v120, v113, s44
    v_perm_b32 v133, v120, v120, s45
    v_mfma_f32_16x16x32_bf16 v[228:231], a[232:235], v[172:175], v[228:231]
    buffer_load_dwordx4 a[164:167], v3, s[60:63], s58 offen offset:1024 sc1
    v_mfma_f32_16x16x32_bf16 v[236:239], a[236:239], v[172:175], v[236:239]
    v_add_f32 v80, v132, v96
    v_add_f32 v81, v133, v97
    v_mfma_f32_16x16x32_bf16 v[244:247], a[240:243], v[172:175], v[244:247]
    v_perm_b32 v134, v121, v120, s44
    s_waitcnt lgkmcnt(3)
    v_mfma_f32_16x16x32_bf16 v[224:227], a[244:247], v[176:179], v[224:227]
    ds_read_b128 v[160:163], v7 offset:38912
    v_perm_b32 v135, v121, v121, s45
    v_add_f32 v82, v134, v98
    v_mfma_f32_16x16x32_bf16 v[232:235], a[248:251], v[176:179], v[232:235]
    buffer_load_dwordx4 a[168:171], v3, s[60:63], s58 offen offset:2048 sc1
    v_mfma_f32_16x16x32_bf16 v[240:243], a[252:255], v[176:179], v[240:243]
    ds_read_b128 v[164:167], v8 offset:38912
    v_add_f32 v83, v135, v99
    v_perm_b32 v132, v122, v121, s44
    v_mfma_f32_16x16x32_bf16 v[228:231], a[244:247], v[180:183], v[228:231]
    v_perm_b32 v133, v122, v122, s45
    v_add_f32 v84, v132, v100
    v_mfma_f32_16x16x32_bf16 v[236:239], a[248:251], v[180:183], v[236:239]
    v_add_f32 v85, v133, v101
    v_perm_b32 v134, v123, v122, s44
    v_mfma_f32_16x16x32_bf16 v[244:247], a[252:255], v[180:183], v[244:247]
    v_perm_b32 v135, v123, v123, s45
    s_waitcnt lgkmcnt(2)
    v_mfma_f32_16x16x32_bf16 v[224:227], v[32:35], v[184:187], v[224:227]
    ds_read_b128 v[168:171], v9 offset:20992
    buffer_load_dwordx4 a[172:175], v3, s[60:63], s58 offen offset:3072 sc1
    v_mfma_f32_16x16x32_bf16 v[232:235], v[36:39], v[184:187], v[232:235]
    v_add_f32 v86, v134, v102
    v_add_f32 v87, v135, v103
    v_mfma_f32_16x16x32_bf16 v[240:243], v[40:43], v[184:187], v[240:243]
    ds_read_b128 v[172:175], v10 offset:20992
    v_perm_b32 v132, v124, v114, s44
    v_perm_b32 v133, v124, v124, s45
    v_mfma_f32_16x16x32_bf16 v[228:231], v[32:35], v[188:191], v[228:231]
    buffer_load_dwordx4 a[176:179], v4, s[60:63], s58 offen offset:0 sc1
    v_mfma_f32_16x16x32_bf16 v[236:239], v[36:39], v[188:191], v[236:239]
    v_add_f32 v88, v132, v88
    v_add_f32 v89, v133, v89
    v_mfma_f32_16x16x32_bf16 v[244:247], v[40:43], v[188:191], v[244:247]
    v_perm_b32 v134, v125, v124, s44
    s_waitcnt lgkmcnt(2)
    v_mfma_f32_16x16x32_bf16 v[224:227], v[44:47], v[160:163], v[224:227]
    v_perm_b32 v135, v125, v125, s45
    v_add_f32 v90, v134, v90
    v_mfma_f32_16x16x32_bf16 v[232:235], v[48:51], v[160:163], v[232:235]
    buffer_load_dwordx4 v[200:203], v13, s[64:67], s4 offen offset:0 sc1
    v_mfma_f32_16x16x32_bf16 v[240:243], v[52:55], v[160:163], v[240:243]
    v_add_f32 v91, v135, v91
    v_perm_b32 v132, v126, v125, s44
    v_mfma_f32_16x16x32_bf16 v[228:231], v[44:47], v[164:167], v[228:231]
    v_perm_b32 v133, v126, v126, s45
    v_add_f32 v92, v132, v92
    v_mfma_f32_16x16x32_bf16 v[236:239], v[48:51], v[164:167], v[236:239]
    v_add_f32 v93, v133, v93
    v_perm_b32 v134, v127, v126, s44
    v_mfma_f32_16x16x32_bf16 v[244:247], v[52:55], v[164:167], v[244:247]
    v_perm_b32 v135, v127, v127, s45
    s_waitcnt lgkmcnt(0)
    v_mfma_f32_16x16x32_bf16 v[224:227], v[56:59], v[168:171], v[224:227]
    buffer_load_dwordx4 v[204:207], v14, s[64:67], s4 offen offset:0 sc1
    v_mfma_f32_16x16x32_bf16 v[232:235], v[60:63], v[168:171], v[232:235]
    v_add_f32 v94, v134, v94
    v_add_f32 v95, v135, v95
    v_mfma_f32_16x16x32_bf16 v[240:243], v[64:67], v[168:171], v[240:243]
    v_perm_b32 v132, v128, v115, s44
    v_perm_b32 v133, v128, v128, s45
    v_mfma_f32_16x16x32_bf16 v[252:255], v[68:71], v[168:171], v[252:255]
    buffer_load_dwordx4 v[208:211], v13, s[64:67], s5 offen offset:0 sc1
    v_mfma_f32_16x16x32_bf16 v[228:231], v[56:59], v[172:175], v[228:231]
    v_add_f32 v96, v132, v96
    v_add_f32 v97, v133, v97
    v_mfma_f32_16x16x32_bf16 v[236:239], v[60:63], v[172:175], v[236:239]
    v_perm_b32 v134, v129, v128, s44
    v_perm_b32 v135, v129, v129, s45
    v_mfma_f32_16x16x32_bf16 v[244:247], v[64:67], v[172:175], v[244:247]
    v_add_f32 v98, v134, v98
    v_add_f32 v99, v135, v99
    v_perm_b32 v132, v130, v129, s44
    buffer_load_dwordx4 v[212:215], v14, s[64:67], s5 offen offset:0 sc1
    v_perm_b32 v133, v130, v130, s45
    v_add_f32 v100, v132, v100
    v_add_f32 v101, v133, v101
    v_perm_b32 v134, v131, v130, s44
    v_perm_b32 v135, v131, v131, s45
    v_add_f32 v102, v134, v102
    v_add_f32 v103, v135, v103
    v_mfma_f32_16x16x32_bf16 v[32:35], v[140:143], v[192:195], 0
    v_mfma_f32_16x16x32_bf16 v[36:39], v[144:147], v[192:195], 0
    buffer_load_dwordx4 v[216:219], v13, s[64:67], s15 offen offset:0 sc1
    v_mfma_f32_16x16x32_bf16 v[40:43], v[148:151], v[192:195], 0
    v_mfma_f32_16x16x32_bf16 v[44:47], v[152:155], v[192:195], 0
    v_max_f32 v224, 0, v224
    v_max_f32 v225, 0, v225
    v_mfma_f32_16x16x32_bf16 v[48:51], v[156:159], v[192:195], 0
    v_max_f32 v226, 0, v226
    v_max_f32 v227, 0, v227
    v_mfma_f32_16x16x32_bf16 v[52:55], v[140:143], v[196:199], 0
    buffer_load_dwordx4 v[220:223], v14, s[64:67], s15 offen offset:0 sc1
    v_mfma_f32_16x16x32_bf16 v[56:59], v[144:147], v[196:199], 0
    v_mul_f32 v224, v224, v224
    v_mul_f32 v225, v225, v225
    v_mfma_f32_16x16x32_bf16 v[60:63], v[148:151], v[196:199], 0
    v_mul_f32 v226, v226, v226
    v_mul_f32 v227, v227, v227
    v_mfma_f32_16x16x32_bf16 v[64:67], v[152:155], v[196:199], 0
    v_cvt_pk_bf16_f32 v224, v224, v225
    v_cvt_pk_bf16_f32 v225, v226, v227
    v_mfma_f32_16x16x32_bf16 v[68:71], v[156:159], v[196:199], 0
    buffer_load_dwordx4 v[104:107], v13, s[64:67], s16 offen offset:0 sc1
    v_max_f32 v232, 0, v232
    v_max_f32 v233, 0, v233
    v_max_f32 v234, 0, v234
    v_max_f32 v235, 0, v235
    v_mul_f32 v232, v232, v232
    v_mul_f32 v233, v233, v233
    v_mul_f32 v234, v234, v234
    v_mul_f32 v235, v235, v235
    v_cvt_pk_bf16_f32 v226, v232, v233
    buffer_load_dwordx4 v[108:111], v14, s[64:67], s16 offen offset:0 sc1
    v_cvt_pk_bf16_f32 v227, v234, v235
    v_or_b32 v224, v11, v224
    v_or_b32 v227, v12, v227
    buffer_store_dwordx4 v[224:227], v13, s[64:67], s40 offen offset:2048 sc1
    v_max_f32 v228, 0, v228
    v_max_f32 v229, 0, v229
    v_max_f32 v230, 0, v230
    v_max_f32 v231, 0, v231
    v_mul_f32 v228, v228, v228
    v_mul_f32 v229, v229, v229
    v_mul_f32 v230, v230, v230
    v_mul_f32 v231, v231, v231
    v_cvt_pk_bf16_f32 v228, v228, v229
    v_cvt_pk_bf16_f32 v229, v230, v231
    v_max_f32 v236, 0, v236
    v_max_f32 v237, 0, v237
    v_max_f32 v238, 0, v238
    v_max_f32 v239, 0, v239
    v_mul_f32 v236, v236, v236
    v_mul_f32 v237, v237, v237
    v_mul_f32 v238, v238, v238
    v_mul_f32 v239, v239, v239
    v_cvt_pk_bf16_f32 v230, v236, v237
    v_cvt_pk_bf16_f32 v231, v238, v239
    v_or_b32 v228, v11, v228
    buffer_load_dwordx4 v[112:115], v13, s[64:67], s17 offen offset:0 sc1
    v_or_b32 v231, v12, v231
    buffer_store_dwordx4 v[228:231], v14, s[64:67], s40 offen offset:2048 sc1
    v_max_f32 v240, 0, v240
    v_max_f32 v241, 0, v241
    v_max_f32 v242, 0, v242
    v_max_f32 v243, 0, v243
    v_mul_f32 v240, v240, v240
    v_mul_f32 v241, v241, v241
    v_mul_f32 v242, v242, v242
    v_mul_f32 v243, v243, v243
    v_cvt_pk_bf16_f32 v240, v240, v241
    v_cvt_pk_bf16_f32 v241, v242, v243
    v_max_f32 v244, 0, v244
    v_max_f32 v245, 0, v245
    v_max_f32 v246, 0, v246
    v_max_f32 v247, 0, v247
    v_mul_f32 v244, v244, v244
    v_mul_f32 v245, v245, v245
    v_mul_f32 v246, v246, v246
    v_mul_f32 v247, v247, v247
    v_cvt_pk_bf16_f32 v242, v244, v245
    v_cvt_pk_bf16_f32 v243, v246, v247
    s_nop 0
    v_permlane32_swap_b32 v240, v242
    v_permlane32_swap_b32 v241, v243
    v_or_b32 v240, v11, v240
    buffer_load_dwordx4 v[116:119], v14, s[64:67], s17 offen offset:0 sc1
    v_or_b32 v243, v12, v243
    buffer_store_dwordx4 v[240:243], v15, s[64:67], s41 offen offset:2048 sc1
    v_add_f32 v248, v248, v252
    v_add_f32 v249, v249, v253
    v_add_f32 v250, v250, v254
    v_add_f32 v251, v251, v255
    v_max_f32 v248, 0, v248
    v_max_f32 v249, 0, v249
    v_max_f32 v250, 0, v250
    v_max_f32 v251, 0, v251
    v_mul_f32 v248, v248, v248
    v_mul_f32 v249, v249, v249
    v_mul_f32 v250, v250, v250
    v_mul_f32 v251, v251, v251
    v_cvt_pk_bf16_f32 v248, v248, v249
    v_cvt_pk_bf16_f32 v249, v250, v251
    s_nop 0
    v_permlane32_swap_b32 v248, v250
    v_permlane32_swap_b32 v249, v251
    v_or_b32 v248, v11, v248
    v_or_b32 v251, v12, v251
    buffer_store_dwordx4 v[248:251], v18, s[64:67], s42 offen offset:2048 sc1
    v_xor_b32 v224, v11, v224
    v_xor_b32 v227, v12, v227
    v_xor_b32 v228, v11, v228
    v_xor_b32 v231, v12, v231
    s_cmp_eq_u32 s3, 3
    s_cselect_b32 s24, 0, -1
    v_and_b32 v5, s24, v11
    v_and_b32 v6, s24, v12
    buffer_load_dwordx4 v[120:123], v13, s[64:67], s43 offen offset:0 sc1
    s_waitcnt vmcnt(13)
    v_xor_b32 v200, v11, v200
    v_xor_b32 v203, v12, v203
    v_xor_b32 v204, v11, v204
    v_xor_b32 v207, v12, v207
    v_or3_b32 v21, v200, v203, v204
    v_or_b32 v21, v21, v207
    v_and_b32 v21, 0x80008000, v21
    v_cmp_ne_u32 vcc, 0, v21
    s_cbranch_vccnz L_vsr0
L_vgr0:
    v_mfma_f32_16x16x32_bf16 v[32:35], a[52:55], v[200:203], v[32:35]
    buffer_load_dwordx4 v[124:127], v14, s[64:67], s43 offen offset:0 sc1
    buffer_load_dwordx4 v[128:131], v13, s[64:67], s56 offen offset:0 sc1
    buffer_load_dwordx4 v[132:135], v14, s[64:67], s56 offen offset:0 sc1
    buffer_load_dwordx4 v[136:139], v13, s[64:67], s57 offen offset:0 sc1
    s_waitcnt vmcnt(13)
    v_xor_b32 v208, v11, v208
    v_mfma_f32_16x16x32_bf16 v[36:39], a[56:59], v[200:203], v[36:39]
    v_xor_b32 v211, v12, v211
    v_xor_b32 v212, v11, v212
    v_mfma_f32_16x16x32_bf16 v[40:43], a[60:63], v[200:203], v[40:43]
    v_xor_b32 v215, v12, v215
    v_or3_b32 v21, v208, v211, v212
    v_mfma_f32_16x16x32_bf16 v[44:47], a[68:71], v[200:203], v[44:47]
    v_xor_b32 v216, v11, v216
    v_xor_b32 v219, v12, v219
    v_mfma_f32_16x16x32_bf16 v[48:51], a[72:75], v[200:203], v[48:51]
    buffer_load_dwordx4 v[160:163], v14, s[64:67], s57 offen offset:0 sc1
    v_mfma_f32_16x16x32_bf16 v[52:55], a[52:55], v[204:207], v[52:55]
    v_or3_b32 v21, v21, v215, v216
    v_xor_b32 v220, v11, v220
    v_mfma_f32_16x16x32_bf16 v[56:59], a[56:59], v[204:207], v[56:59]
    v_xor_b32 v223, v12, v223
    v_or3_b32 v21, v21, v219, v220
    v_mfma_f32_16x16x32_bf16 v[60:63], a[60:63], v[204:207], v[60:63]
    v_or_b32 v21, v21, v223
    v_and_b32 v21, 0x80008000, v21
    v_mfma_f32_16x16x32_bf16 v[64:67], a[68:71], v[204:207], v[64:67]
    buffer_load_dwordx4 v[164:167], v13, s[64:67], s58 offen offset:0 sc1
    v_mfma_f32_16x16x32_bf16 v[68:71], a[72:75], v[204:207], v[68:71]
    v_cmp_ne_u32 vcc, 0, v21
    s_cbranch_vccnz L_vsr1
L_vgr1:
    v_mfma_f32_16x16x32_bf16 v[32:35], a[76:79], v[208:211], v[32:35]
    v_mfma_f32_16x16x32_bf16 v[36:39], a[80:83], v[208:211], v[36:39]
    buffer_load_dwordx4 v[168:171], v14, s[64:67], s58 offen offset:0 sc1
    v_mfma_f32_16x16x32_bf16 v[40:43], a[88:91], v[208:211], v[40:43]
    v_mfma_f32_16x16x32_bf16 v[44:47], a[92:95], v[208:211], v[44:47]
    v_mfma_f32_16x16x32_bf16 v[48:51], a[100:103], v[208:211], v[48:51]
    v_mfma_f32_16x16x32_bf16 v[52:55], a[76:79], v[212:215], v[52:55]
    buffer_load_dwordx4 a[180:183], v3, s[60:63], s59 offen offset:0 sc1
    v_mfma_f32_16x16x32_bf16 v[56:59], a[80:83], v[212:215], v[56:59]
    v_mfma_f32_16x16x32_bf16 v[60:63], a[88:91], v[212:215], v[60:63]
    s_waitcnt vmcnt(11)
    v_xor_b32 v104, v11, v104
    v_mfma_f32_16x16x32_bf16 v[64:67], a[92:95], v[212:215], v[64:67]
    buffer_load_dwordx4 a[184:187], v3, s[60:63], s59 offen offset:1024 sc1
    v_mfma_f32_16x16x32_bf16 v[68:71], a[100:103], v[212:215], v[68:71]
    v_xor_b32 v107, v12, v107
    v_xor_b32 v108, v11, v108
    v_mfma_f32_16x16x32_bf16 v[32:35], a[104:107], v[216:219], v[32:35]
    v_xor_b32 v111, v12, v111
    v_or3_b32 v21, v104, v107, v108
    v_mfma_f32_16x16x32_bf16 v[36:39], a[108:111], v[216:219], v[36:39]
    v_xor_b32 v112, v11, v112
    v_xor_b32 v115, v12, v115
    v_mfma_f32_16x16x32_bf16 v[40:43], a[116:119], v[216:219], v[40:43]
    buffer_load_dwordx4 a[188:191], v3, s[60:63], s59 offen offset:2048 sc1
    v_mfma_f32_16x16x32_bf16 v[44:47], a[120:123], v[216:219], v[44:47]
    v_or3_b32 v21, v21, v111, v112
    v_xor_b32 v116, v11, v116
    v_mfma_f32_16x16x32_bf16 v[48:51], a[128:131], v[216:219], v[48:51]
    v_xor_b32 v119, v12, v119
    v_or3_b32 v21, v21, v115, v116
    v_mfma_f32_16x16x32_bf16 v[52:55], a[104:107], v[220:223], v[52:55]
    v_or_b32 v21, v21, v119
    v_and_b32 v21, 0x80008000, v21
    v_mfma_f32_16x16x32_bf16 v[56:59], a[108:111], v[220:223], v[56:59]
    buffer_load_dwordx4 a[192:195], v3, s[60:63], s59 offen offset:3072 sc1
    v_mfma_f32_16x16x32_bf16 v[60:63], a[116:119], v[220:223], v[60:63]
    v_cmp_ne_u32 vcc, 0, v21
    s_cbranch_vccnz L_vsr2
L_vgr2:
    v_mfma_f32_16x16x32_bf16 v[64:67], a[120:123], v[220:223], v[64:67]
    v_mfma_f32_16x16x32_bf16 v[68:71], a[128:131], v[220:223], v[68:71]
    buffer_load_dwordx4 a[196:199], v4, s[60:63], s59 offen offset:0 sc1
    s_barrier
    v_mfma_f32_16x16x32_bf16 v[32:35], a[132:135], v[104:107], v[32:35]
    v_mfma_f32_16x16x32_bf16 v[36:39], a[0:3], v[104:107], v[36:39]
    v_mfma_f32_16x16x32_bf16 v[40:43], a[4:7], v[104:107], v[40:43]
    v_mfma_f32_16x16x32_bf16 v[44:47], a[8:11], v[104:107], v[44:47]
    buffer_load_dwordx4 a[200:203], v3, s[60:63], s73 offen offset:0 sc1
    v_mfma_f32_16x16x32_bf16 v[48:51], a[12:15], v[104:107], v[48:51]
    v_mfma_f32_16x16x32_bf16 v[52:55], a[132:135], v[108:111], v[52:55]
    v_mfma_f32_16x16x32_bf16 v[56:59], a[0:3], v[108:111], v[56:59]
    buffer_load_dwordx4 a[204:207], v3, s[60:63], s73 offen offset:1024 sc1
    v_mfma_f32_16x16x32_bf16 v[60:63], a[4:7], v[108:111], v[60:63]
    s_waitcnt vmcnt(11)
    v_xor_b32 v120, v11, v120
    v_mfma_f32_16x16x32_bf16 v[64:67], a[8:11], v[108:111], v[64:67]
    v_xor_b32 v123, v12, v123
    v_xor_b32 v124, v11, v124
    v_mfma_f32_16x16x32_bf16 v[68:71], a[12:15], v[108:111], v[68:71]
    v_xor_b32 v127, v12, v127
    v_or3_b32 v21, v120, v123, v124
    v_mfma_f32_16x16x32_bf16 v[32:35], a[16:19], v[112:115], v[32:35]
    buffer_load_dwordx4 a[208:211], v3, s[60:63], s73 offen offset:2048 sc1
    v_mfma_f32_16x16x32_bf16 v[36:39], a[20:23], v[112:115], v[36:39]
    v_xor_b32 v128, v11, v128
    v_xor_b32 v131, v12, v131
    v_mfma_f32_16x16x32_bf16 v[40:43], a[24:27], v[112:115], v[40:43]
    v_or3_b32 v21, v21, v127, v128
    v_xor_b32 v132, v11, v132
    v_mfma_f32_16x16x32_bf16 v[44:47], a[28:31], v[112:115], v[44:47]
    buffer_load_dwordx4 a[212:215], v3, s[60:63], s73 offen offset:3072 sc1
    v_mfma_f32_16x16x32_bf16 v[48:51], a[32:35], v[112:115], v[48:51]
    v_xor_b32 v135, v12, v135
    v_or3_b32 v21, v21, v131, v132
    v_mfma_f32_16x16x32_bf16 v[52:55], a[16:19], v[116:119], v[52:55]
    v_or_b32 v21, v21, v135
    v_and_b32 v21, 0x80008000, v21
    v_mfma_f32_16x16x32_bf16 v[56:59], a[20:23], v[116:119], v[56:59]
    v_cmp_ne_u32 vcc, 0, v21
    s_cbranch_vccnz L_vsr3
L_vgr3:
    v_mfma_f32_16x16x32_bf16 v[60:63], a[24:27], v[116:119], v[60:63]
    buffer_load_dwordx4 a[216:219], v4, s[60:63], s73 offen offset:0 sc1
    v_mfma_f32_16x16x32_bf16 v[64:67], a[28:31], v[116:119], v[64:67]
    v_mfma_f32_16x16x32_bf16 v[68:71], a[32:35], v[116:119], v[68:71]
    v_mfma_f32_16x16x32_bf16 v[32:35], a[36:39], v[120:123], v[32:35]
    buffer_load_dwordx4 v[172:175], v13, s[64:67], s59 offen offset:0 sc1
    v_mfma_f32_16x16x32_bf16 v[36:39], a[40:43], v[120:123], v[36:39]
    v_mfma_f32_16x16x32_bf16 v[40:43], a[44:47], v[120:123], v[40:43]
    v_mfma_f32_16x16x32_bf16 v[44:47], a[48:51], v[120:123], v[44:47]
    v_mfma_f32_16x16x32_bf16 v[48:51], a[64:67], v[120:123], v[48:51]
    buffer_load_dwordx4 v[176:179], v14, s[64:67], s59 offen offset:0 sc1
    v_mfma_f32_16x16x32_bf16 v[52:55], a[36:39], v[124:127], v[52:55]
    v_mfma_f32_16x16x32_bf16 v[56:59], a[40:43], v[124:127], v[56:59]
    v_mfma_f32_16x16x32_bf16 v[60:63], a[44:47], v[124:127], v[60:63]
    s_waitcnt vmcnt(12)
    v_xor_b32 v136, v11, v136
    v_mfma_f32_16x16x32_bf16 v[64:67], a[48:51], v[124:127], v[64:67]
    buffer_load_dwordx4 v[180:183], v13, s[64:67], s73 offen offset:0 sc1
    v_mfma_f32_16x16x32_bf16 v[68:71], a[64:67], v[124:127], v[68:71]
    v_xor_b32 v139, v12, v139
    v_xor_b32 v160, v11, v160
    v_mfma_f32_16x16x32_bf16 v[32:35], a[84:87], v[128:131], v[32:35]
    v_xor_b32 v163, v12, v163
    v_or3_b32 v21, v136, v139, v160
    v_mfma_f32_16x16x32_bf16 v[36:39], a[96:99], v[128:131], v[36:39]
    buffer_load_dwordx4 v[184:187], v14, s[64:67], s73 offen offset:0 sc1
    v_mfma_f32_16x16x32_bf16 v[40:43], a[112:115], v[128:131], v[40:43]
    v_xor_b32 v164, v11, v164
    v_xor_b32 v167, v12, v167
    v_mfma_f32_16x16x32_bf16 v[44:47], a[124:127], v[128:131], v[44:47]
    v_or3_b32 v21, v21, v163, v164
    v_xor_b32 v168, v11, v168
    v_mfma_f32_16x16x32_bf16 v[48:51], a[136:139], v[128:131], v[48:51]
    v_xor_b32 v171, v12, v171
    v_or3_b32 v21, v21, v167, v168
    v_mfma_f32_16x16x32_bf16 v[52:55], a[84:87], v[132:135], v[52:55]
    buffer_load_dwordx4 v[188:191], v13, s[64:67], s4 offen offset:2048 sc1
    v_mfma_f32_16x16x32_bf16 v[56:59], a[96:99], v[132:135], v[56:59]
    v_or_b32 v21, v21, v171
    v_and_b32 v21, 0x80008000, v21
    v_mfma_f32_16x16x32_bf16 v[60:63], a[112:115], v[132:135], v[60:63]
    v_cmp_ne_u32 vcc, 0, v21
    s_cbranch_vccnz L_vsr4
L_vgr4:
    v_mfma_f32_16x16x32_bf16 v[64:67], a[124:127], v[132:135], v[64:67]
    buffer_load_dwordx4 v[104:107], v14, s[64:67], s4 offen offset:2048 sc1
    v_mfma_f32_16x16x32_bf16 v[68:71], a[136:139], v[132:135], v[68:71]
    v_mfma_f32_16x16x32_bf16 v[32:35], a[140:143], v[136:139], v[32:35]
    v_mfma_f32_16x16x32_bf16 v[36:39], a[144:147], v[136:139], v[36:39]
    v_mfma_f32_16x16x32_bf16 v[40:43], a[148:151], v[136:139], v[40:43]
    buffer_load_dwordx4 v[108:111], v13, s[64:67], s5 offen offset:2048 sc1
    v_mfma_f32_16x16x32_bf16 v[44:47], a[152:155], v[136:139], v[44:47]
    v_mfma_f32_16x16x32_bf16 v[48:51], a[156:159], v[136:139], v[48:51]
    v_mfma_f32_16x16x32_bf16 v[52:55], a[140:143], v[160:163], v[52:55]
    v_mfma_f32_16x16x32_bf16 v[56:59], a[144:147], v[160:163], v[56:59]
    buffer_load_dwordx4 v[112:115], v14, s[64:67], s5 offen offset:2048 sc1
    v_mfma_f32_16x16x32_bf16 v[60:63], a[148:151], v[160:163], v[60:63]
    buffer_load_dwordx4 v[116:119], v13, s[64:67], s15 offen offset:2048 sc1
    buffer_load_dwordx4 v[120:123], v14, s[64:67], s15 offen offset:2048 sc1
    buffer_load_dwordx4 a[220:223], v3, s[60:63], s74 offen offset:0 sc1
    buffer_load_dwordx4 a[224:227], v3, s[60:63], s74 offen offset:1024 sc1
    buffer_load_dwordx4 a[228:231], v3, s[60:63], s74 offen offset:2048 sc1
    s_waitcnt vmcnt(9)
    v_xor_b32 v172, v11, v172
    v_mfma_f32_16x16x32_bf16 v[64:67], a[152:155], v[160:163], v[64:67]
    v_xor_b32 v175, v12, v175
    v_xor_b32 v176, v11, v176
    v_mfma_f32_16x16x32_bf16 v[68:71], a[156:159], v[160:163], v[68:71]
    v_xor_b32 v179, v12, v179
    v_or3_b32 v21, v172, v175, v176
    v_mfma_f32_16x16x32_bf16 v[32:35], a[160:163], v[164:167], v[32:35]
    v_xor_b32 v180, v11, v180
    v_xor_b32 v183, v12, v183
    v_mfma_f32_16x16x32_bf16 v[36:39], a[164:167], v[164:167], v[36:39]
    buffer_load_dwordx4 a[232:235], v3, s[60:63], s74 offen offset:3072 sc1
    v_mfma_f32_16x16x32_bf16 v[40:43], a[168:171], v[164:167], v[40:43]
    v_or3_b32 v21, v21, v179, v180
    v_xor_b32 v184, v11, v184
    v_mfma_f32_16x16x32_bf16 v[44:47], a[172:175], v[164:167], v[44:47]
    v_xor_b32 v187, v12, v187
    v_or3_b32 v21, v21, v183, v184
    v_mfma_f32_16x16x32_bf16 v[48:51], a[176:179], v[164:167], v[48:51]
    v_or_b32 v21, v21, v187
    v_and_b32 v21, 0x80008000, v21
    v_mfma_f32_16x16x32_bf16 v[52:55], a[160:163], v[168:171], v[52:55]
    buffer_load_dwordx4 a[236:239], v4, s[60:63], s74 offen offset:0 sc1
    v_mfma_f32_16x16x32_bf16 v[56:59], a[164:167], v[168:171], v[56:59]
    v_cmp_ne_u32 vcc, 0, v21
    s_cbranch_vccnz L_vsr5
L_vgr5:
    v_mfma_f32_16x16x32_bf16 v[60:63], a[168:171], v[168:171], v[60:63]
    v_mfma_f32_16x16x32_bf16 v[64:67], a[172:175], v[168:171], v[64:67]
    buffer_load_dwordx4 a[240:243], v3, s[60:63], s75 offen offset:0 sc1
    v_mfma_f32_16x16x32_bf16 v[68:71], a[176:179], v[168:171], v[68:71]
    v_mfma_f32_16x16x32_bf16 v[32:35], a[180:183], v[172:175], v[32:35]
    v_mfma_f32_16x16x32_bf16 v[36:39], a[184:187], v[172:175], v[36:39]
    v_mfma_f32_16x16x32_bf16 v[40:43], a[188:191], v[172:175], v[40:43]
    buffer_load_dwordx4 a[244:247], v3, s[60:63], s75 offen offset:1024 sc1
    v_mfma_f32_16x16x32_bf16 v[44:47], a[192:195], v[172:175], v[44:47]
    v_mfma_f32_16x16x32_bf16 v[48:51], a[196:199], v[172:175], v[48:51]
    v_mfma_f32_16x16x32_bf16 v[52:55], a[180:183], v[176:179], v[52:55]
    buffer_load_dwordx4 a[248:251], v3, s[60:63], s75 offen offset:2048 sc1
    v_mfma_f32_16x16x32_bf16 v[56:59], a[184:187], v[176:179], v[56:59]
    v_mfma_f32_16x16x32_bf16 v[60:63], a[188:191], v[176:179], v[60:63]
    s_waitcnt vmcnt(12)
    v_xor_b32 v188, v11, v188
    v_mfma_f32_16x16x32_bf16 v[64:67], a[192:195], v[176:179], v[64:67]
    v_xor_b32 v191, v12, v191
    v_xor_b32 v104, v11, v104
    v_mfma_f32_16x16x32_bf16 v[68:71], a[196:199], v[176:179], v[68:71]
    buffer_load_dwordx4 a[252:255], v3, s[60:63], s75 offen offset:3072 sc1
    v_mfma_f32_16x16x32_bf16 v[32:35], a[200:203], v[180:183], v[32:35]
    v_xor_b32 v107, v12, v107
    v_or3_b32 v21, v188, v191, v104
    v_mfma_f32_16x16x32_bf16 v[36:39], a[204:207], v[180:183], v[36:39]
    v_or_b32 v21, v21, v107
    v_and_b32 v21, 0x80008000, v21
    v_mfma_f32_16x16x32_bf16 v[40:43], a[208:211], v[180:183], v[40:43]
    v_cmp_ne_u32 vcc, 0, v21
    s_cbranch_vccnz L_vsr6
L_vgr6:
    v_mfma_f32_16x16x32_bf16 v[44:47], a[212:215], v[180:183], v[44:47]
    buffer_load_dwordx4 v[124:127], v13, s[64:67], s74 offen offset:0 sc1
    v_mfma_f32_16x16x32_bf16 v[48:51], a[216:219], v[180:183], v[48:51]
    v_mfma_f32_16x16x32_bf16 v[52:55], a[200:203], v[184:187], v[52:55]
    v_mfma_f32_16x16x32_bf16 v[56:59], a[204:207], v[184:187], v[56:59]
    buffer_load_dwordx4 v[128:131], v13, s[64:67], s75 offen offset:0 sc1
    v_mfma_f32_16x16x32_bf16 v[60:63], a[208:211], v[184:187], v[60:63]
    v_mfma_f32_16x16x32_bf16 v[64:67], a[212:215], v[184:187], v[64:67]
    v_mfma_f32_16x16x32_bf16 v[68:71], a[216:219], v[184:187], v[68:71]
    v_mfma_f32_16x16x32_bf16 v[200:203], v[140:143], v[224:227], 0
    buffer_load_dwordx4 v[132:135], v14, s[64:67], s74 offen offset:0 sc1
    v_mfma_f32_16x16x32_bf16 v[204:207], v[144:147], v[224:227], 0
    v_mfma_f32_16x16x32_bf16 v[208:211], v[148:151], v[224:227], 0
    v_mfma_f32_16x16x32_bf16 v[212:215], v[152:155], v[224:227], 0
    buffer_load_dwordx4 v[136:139], v14, s[64:67], s75 offen offset:0 sc1
    v_mfma_f32_16x16x32_bf16 v[216:219], v[156:159], v[224:227], 0
    v_mfma_f32_16x16x32_bf16 v[220:223], v[140:143], v[228:231], 0
    v_mfma_f32_16x16x32_bf16 v[232:235], v[144:147], v[228:231], 0
    v_mfma_f32_16x16x32_bf16 v[236:239], v[148:151], v[228:231], 0
    buffer_load_dwordx4 v[160:163], v13, s[64:67], s16 offen offset:2048 sc1
    v_mfma_f32_16x16x32_bf16 v[240:243], v[152:155], v[228:231], 0
    s_waitcnt vmcnt(14)
    v_xor_b32 v108, v11, v108
    v_mfma_f32_16x16x32_bf16 v[244:247], v[156:159], v[228:231], 0
    v_xor_b32 v111, v12, v111
    v_xor_b32 v112, v11, v112
    v_mfma_f32_16x16x32_bf16 v[200:203], a[52:55], v[188:191], v[200:203]
    v_xor_b32 v115, v12, v115
    v_or3_b32 v21, v108, v111, v112
    v_mfma_f32_16x16x32_bf16 v[204:207], a[56:59], v[188:191], v[204:207]
    buffer_load_dwordx4 v[164:167], v14, s[64:67], s16 offen offset:2048 sc1
    v_mfma_f32_16x16x32_bf16 v[208:211], a[60:63], v[188:191], v[208:211]
    v_xor_b32 v116, v11, v116
    v_xor_b32 v119, v12, v119
    v_mfma_f32_16x16x32_bf16 v[212:215], a[68:71], v[188:191], v[212:215]
    v_or3_b32 v21, v21, v115, v116
    v_xor_b32 v120, v11, v120
    v_mfma_f32_16x16x32_bf16 v[216:219], a[72:75], v[188:191], v[216:219]
    buffer_load_dwordx4 v[168:171], v13, s[64:67], s17 offen offset:2048 sc1
    v_mfma_f32_16x16x32_bf16 v[220:223], a[52:55], v[104:107], v[220:223]
    v_xor_b32 v123, v12, v123
    v_or3_b32 v21, v21, v119, v120
    v_mfma_f32_16x16x32_bf16 v[232:235], a[56:59], v[104:107], v[232:235]
    v_or_b32 v21, v21, v123
    v_and_b32 v21, 0x80008000, v21
    v_mfma_f32_16x16x32_bf16 v[236:239], a[60:63], v[104:107], v[236:239]
    v_cmp_ne_u32 vcc, 0, v21
    s_cbranch_vccnz L_vsr7
L_vgr7:
    v_mfma_f32_16x16x32_bf16 v[240:243], a[68:71], v[104:107], v[240:243]
    buffer_load_dwordx4 a[52:55], v4, s[60:63], s75 offen offset:0 sc1
    v_mfma_f32_16x16x32_bf16 v[244:247], a[72:75], v[104:107], v[244:247]
    v_mfma_f32_16x16x32_bf16 v[200:203], a[76:79], v[108:111], v[200:203]
    v_mfma_f32_16x16x32_bf16 v[204:207], a[80:83], v[108:111], v[204:207]
    buffer_load_dwordx4 v[172:175], v14, s[64:67], s17 offen offset:2048 sc1
    v_mfma_f32_16x16x32_bf16 v[208:211], a[88:91], v[108:111], v[208:211]
    v_mfma_f32_16x16x32_bf16 v[212:215], a[92:95], v[108:111], v[212:215]
    v_mfma_f32_16x16x32_bf16 v[216:219], a[100:103], v[108:111], v[216:219]
    v_mfma_f32_16x16x32_bf16 v[220:223], a[76:79], v[112:115], v[220:223]
    buffer_load_dwordx4 v[176:179], v13, s[64:67], s43 offen offset:2048 sc1
    v_mfma_f32_16x16x32_bf16 v[232:235], a[80:83], v[112:115], v[232:235]
    v_mfma_f32_16x16x32_bf16 v[236:239], a[88:91], v[112:115], v[236:239]
    buffer_load_dwordx4 v[180:183], v14, s[64:67], s43 offen offset:2048 sc1
    buffer_load_dwordx4 v[184:187], v13, s[64:67], s56 offen offset:2048 sc1
    buffer_load_dwordx4 v[140:143], v14, s[64:67], s56 offen offset:2048 sc1
    s_waitcnt vmcnt(9)
    v_xor_b32 v124, v5, v124
    v_mfma_f32_16x16x32_bf16 v[240:243], a[92:95], v[112:115], v[240:243]
    v_xor_b32 v127, v6, v127
    v_xor_b32 v128, v5, v128
    v_mfma_f32_16x16x32_bf16 v[244:247], a[100:103], v[112:115], v[244:247]
    v_xor_b32 v131, v6, v131
    v_or3_b32 v21, v124, v127, v128
    v_mfma_f32_16x16x32_bf16 v[200:203], a[104:107], v[116:119], v[200:203]
    v_xor_b32 v132, v5, v132
    v_xor_b32 v135, v6, v135
    v_mfma_f32_16x16x32_bf16 v[204:207], a[108:111], v[116:119], v[204:207]
    buffer_load_dwordx4 v[144:147], v13, s[64:67], s57 offen offset:2048 sc1
    v_mfma_f32_16x16x32_bf16 v[208:211], a[116:119], v[116:119], v[208:211]
    v_or3_b32 v21, v21, v131, v132
    v_xor_b32 v136, v5, v136
    v_mfma_f32_16x16x32_bf16 v[212:215], a[120:123], v[116:119], v[212:215]
    v_xor_b32 v139, v6, v139
    v_or3_b32 v21, v21, v135, v136
    v_mfma_f32_16x16x32_bf16 v[216:219], a[128:131], v[116:119], v[216:219]
    v_or_b32 v21, v21, v139
    v_and_b32 v21, 0x80008000, v21
    v_mfma_f32_16x16x32_bf16 v[220:223], a[104:107], v[120:123], v[220:223]
    buffer_load_dwordx4 v[148:151], v14, s[64:67], s57 offen offset:2048 sc1
    v_mfma_f32_16x16x32_bf16 v[232:235], a[108:111], v[120:123], v[232:235]
    v_cmp_ne_u32 vcc, 0, v21
    s_cbranch_vccnz L_vsr8
L_vgr8:
    v_mfma_f32_16x16x32_bf16 v[236:239], a[116:119], v[120:123], v[236:239]
    v_mfma_f32_16x16x32_bf16 v[240:243], a[120:123], v[120:123], v[240:243]
    buffer_load_dwordx4 v[152:155], v13, s[64:67], s58 offen offset:2048 sc1
    v_mfma_f32_16x16x32_bf16 v[244:247], a[128:131], v[120:123], v[244:247]
    v_mfma_f32_16x16x32_bf16 v[32:35], a[220:223], v[124:127], v[32:35]
    v_mfma_f32_16x16x32_bf16 v[36:39], a[224:227], v[124:127], v[36:39]
    v_mfma_f32_16x16x32_bf16 v[40:43], a[228:231], v[124:127], v[40:43]
    buffer_load_dwordx4 v[156:159], v14, s[64:67], s58 offen offset:2048 sc1
    v_mfma_f32_16x16x32_bf16 v[44:47], a[232:235], v[124:127], v[44:47]
    v_mfma_f32_16x16x32_bf16 v[48:51], a[236:239], v[124:127], v[48:51]
    s_waitcnt vmcnt(9)
    v_mfma_f32_16x16x32_bf16 v[32:35], a[240:243], v[128:131], v[32:35]
    buffer_load_dwordx4 v[188:191], v13, s[64:67], s59 offen offset:2048 sc1
    v_mfma_f32_16x16x32_bf16 v[36:39], a[244:247], v[128:131], v[36:39]
    v_mfma_f32_16x16x32_bf16 v[40:43], a[248:251], v[128:131], v[40:43]
    s_waitcnt vmcnt(9)
    v_xor_b32 v160, v11, v160
    v_mfma_f32_16x16x32_bf16 v[44:47], a[252:255], v[128:131], v[44:47]
    v_xor_b32 v163, v12, v163
    v_xor_b32 v164, v11, v164
    v_mfma_f32_16x16x32_bf16 v[48:51], a[52:55], v[128:131], v[48:51]
    buffer_load_dwordx4 v[104:107], v14, s[64:67], s59 offen offset:2048 sc1
    v_mfma_f32_16x16x32_bf16 v[52:55], a[220:223], v[132:135], v[52:55]
    v_xor_b32 v167, v12, v167
    v_or3_b32 v21, v160, v163, v164
    v_mfma_f32_16x16x32_bf16 v[56:59], a[224:227], v[132:135], v[56:59]
    v_xor_b32 v168, v11, v168
    v_xor_b32 v171, v12, v171
    v_mfma_f32_16x16x32_bf16 v[60:63], a[228:231], v[132:135], v[60:63]
    ds_write_b128 v29, v[32:35] offset:0
    v_mfma_f32_16x16x32_bf16 v[64:67], a[232:235], v[132:135], v[64:67]
    buffer_load_dwordx4 v[108:111], v13, s[64:67], s73 offen offset:2048 sc1
    v_mfma_f32_16x16x32_bf16 v[68:71], a[236:239], v[132:135], v[68:71]
    v_or3_b32 v21, v21, v167, v168
    v_xor_b32 v172, v11, v172
    v_mfma_f32_16x16x32_bf16 v[52:55], a[240:243], v[136:139], v[52:55]
    ds_write_b128 v29, v[36:39] offset:64
    v_mfma_f32_16x16x32_bf16 v[56:59], a[244:247], v[136:139], v[56:59]
    buffer_load_dwordx4 v[112:115], v14, s[64:67], s73 offen offset:2048 sc1
    v_mfma_f32_16x16x32_bf16 v[60:63], a[248:251], v[136:139], v[60:63]
    v_xor_b32 v175, v12, v175
    v_or3_b32 v21, v21, v171, v172
    v_mfma_f32_16x16x32_bf16 v[64:67], a[252:255], v[136:139], v[64:67]
    ds_write_b128 v29, v[40:43] offset:128
    v_mfma_f32_16x16x32_bf16 v[68:71], a[52:55], v[136:139], v[68:71]
    buffer_load_dwordx4 v[116:119], v13, s[64:67], s74 offen offset:2048 sc1
    v_or_b32 v21, v21, v175
    v_and_b32 v21, 0x80008000, v21
    v_cmp_ne_u32 vcc, 0, v21
    s_cbranch_vccnz L_vsr9
L_vgr9:
    v_mfma_f32_16x16x32_bf16 v[200:203], a[132:135], v[160:163], v[200:203]
    v_mfma_f32_16x16x32_bf16 v[204:207], a[0:3], v[160:163], v[204:207]
    ds_write_b128 v29, v[44:47] offset:192
    v_mfma_f32_16x16x32_bf16 v[208:211], a[4:7], v[160:163], v[208:211]
    buffer_load_dwordx4 v[120:123], v13, s[64:67], s75 offen offset:2048 sc1
    v_mfma_f32_16x16x32_bf16 v[212:215], a[8:11], v[160:163], v[212:215]
    v_mfma_f32_16x16x32_bf16 v[216:219], a[12:15], v[160:163], v[216:219]
    ds_write_b128 v29, v[48:51] offset:256
    v_mfma_f32_16x16x32_bf16 v[220:223], a[132:135], v[164:167], v[220:223]
    buffer_load_dwordx4 v[124:127], v14, s[64:67], s74 offen offset:2048 sc1
    v_mfma_f32_16x16x32_bf16 v[232:235], a[0:3], v[164:167], v[232:235]
    v_mfma_f32_16x16x32_bf16 v[236:239], a[4:7], v[164:167], v[236:239]
    ds_write_b128 v30, v[52:55] offset:0
    v_mfma_f32_16x16x32_bf16 v[240:243], a[8:11], v[164:167], v[240:243]
    buffer_load_dwordx4 v[128:131], v14, s[64:67], s75 offen offset:2048 sc1
    v_mfma_f32_16x16x32_bf16 v[244:247], a[12:15], v[164:167], v[244:247]
    s_waitcnt vmcnt(12)
    v_xor_b32 v176, v11, v176
    v_mfma_f32_16x16x32_bf16 v[200:203], a[16:19], v[168:171], v[200:203]
    ds_write_b128 v30, v[56:59] offset:64
    v_mfma_f32_16x16x32_bf16 v[204:207], a[20:23], v[168:171], v[204:207]
    v_xor_b32 v179, v12, v179
    v_xor_b32 v180, v11, v180
    v_mfma_f32_16x16x32_bf16 v[208:211], a[24:27], v[168:171], v[208:211]
    v_xor_b32 v183, v12, v183
    v_or3_b32 v21, v176, v179, v180
    v_mfma_f32_16x16x32_bf16 v[212:215], a[28:31], v[168:171], v[212:215]
    ds_write_b128 v30, v[60:63] offset:128
    v_mfma_f32_16x16x32_bf16 v[216:219], a[32:35], v[168:171], v[216:219]
    v_xor_b32 v184, v11, v184
    v_xor_b32 v187, v12, v187
    v_mfma_f32_16x16x32_bf16 v[220:223], a[16:19], v[172:175], v[220:223]
    v_or3_b32 v21, v21, v183, v184
    v_xor_b32 v140, v11, v140
    v_mfma_f32_16x16x32_bf16 v[232:235], a[20:23], v[172:175], v[232:235]
    ds_write_b128 v30, v[64:67] offset:192
    v_mfma_f32_16x16x32_bf16 v[236:239], a[24:27], v[172:175], v[236:239]
    v_xor_b32 v143, v12, v143
    v_or3_b32 v21, v21, v187, v140
    v_mfma_f32_16x16x32_bf16 v[240:243], a[28:31], v[172:175], v[240:243]
    v_or_b32 v21, v21, v143
    v_and_b32 v21, 0x80008000, v21
    v_mfma_f32_16x16x32_bf16 v[244:247], a[32:35], v[172:175], v[244:247]
    ds_write_b128 v30, v[68:71] offset:256
    v_cmp_ne_u32 vcc, 0, v21
    s_cbranch_vccnz L_vsr10
L_vgr10:
    v_mfma_f32_16x16x32_bf16 v[200:203], a[36:39], v[176:179], v[200:203]
    s_waitcnt lgkmcnt(0)
    s_barrier
    ds_read_b128 v[32:35], v23 offset:0
    v_mfma_f32_16x16x32_bf16 v[204:207], a[40:43], v[176:179], v[204:207]
    ds_read_b128 v[36:39], v23 offset:10752
    v_mfma_f32_16x16x32_bf16 v[208:211], a[44:47], v[176:179], v[208:211]
    ds_read_b128 v[40:43], v23 offset:21504
    v_mfma_f32_16x16x32_bf16 v[212:215], a[48:51], v[176:179], v[212:215]
    ds_read_b128 v[44:47], v23 offset:32256
    v_mfma_f32_16x16x32_bf16 v[216:219], a[64:67], v[176:179], v[216:219]
    ds_read_b128 v[48:51], v23 offset:16
    v_mfma_f32_16x16x32_bf16 v[220:223], a[36:39], v[180:183], v[220:223]
    ds_read_b128 v[52:55], v23 offset:10768
    v_mfma_f32_16x16x32_bf16 v[232:235], a[40:43], v[180:183], v[232:235]
    ds_read_b128 v[56:59], v23 offset:21520
    v_mfma_f32_16x16x32_bf16 v[236:239], a[44:47], v[180:183], v[236:239]
    s_waitcnt vmcnt(8)
    v_xor_b32 v144, v11, v144
    ds_read_b128 v[60:63], v23 offset:32272
    v_mfma_f32_16x16x32_bf16 v[240:243], a[48:51], v[180:183], v[240:243]
    v_xor_b32 v147, v12, v147
    v_xor_b32 v148, v11, v148
    ds_read_b128 v[64:67], v23 offset:160
    v_mfma_f32_16x16x32_bf16 v[244:247], a[64:67], v[180:183], v[244:247]
    v_xor_b32 v151, v12, v151
    v_or3_b32 v21, v144, v147, v148
    ds_read_b128 v[68:71], v23 offset:10912
    v_mfma_f32_16x16x32_bf16 v[200:203], a[84:87], v[184:187], v[200:203]
    v_xor_b32 v152, v11, v152
    v_xor_b32 v155, v12, v155
    ds_read_b128 v[192:195], v23 offset:21664
    v_mfma_f32_16x16x32_bf16 v[204:207], a[96:99], v[184:187], v[204:207]
    v_or3_b32 v21, v21, v151, v152
    v_xor_b32 v156, v11, v156
    ds_read_b128 v[196:199], v23 offset:32416
    v_mfma_f32_16x16x32_bf16 v[208:211], a[112:115], v[184:187], v[208:211]
    v_xor_b32 v159, v12, v159
    v_or3_b32 v21, v21, v155, v156
    ds_read_b128 v[224:227], v23 offset:176
    v_mfma_f32_16x16x32_bf16 v[212:215], a[124:127], v[184:187], v[212:215]
    v_or_b32 v21, v21, v159
    v_and_b32 v21, 0x80008000, v21
    ds_read_b128 v[228:231], v23 offset:10928
    v_mfma_f32_16x16x32_bf16 v[216:219], a[136:139], v[184:187], v[216:219]
    v_cmp_ne_u32 vcc, 0, v21
    s_cbranch_vccnz L_vsr11
L_vgr11:
    ds_read_b128 v[248:251], v23 offset:21680
    v_mfma_f32_16x16x32_bf16 v[220:223], a[84:87], v[140:143], v[220:223]
    ds_read_b128 v[252:255], v23 offset:32432
    v_mfma_f32_16x16x32_bf16 v[232:235], a[96:99], v[140:143], v[232:235]
    v_mfma_f32_16x16x32_bf16 v[236:239], a[112:115], v[140:143], v[236:239]
    s_waitcnt lgkmcnt(12)
    v_add_f32 v32, v32, v36
    v_mfma_f32_16x16x32_bf16 v[240:243], a[124:127], v[140:143], v[240:243]
    v_add_f32 v33, v33, v37
    v_add_f32 v34, v34, v38
    v_mfma_f32_16x16x32_bf16 v[244:247], a[136:139], v[140:143], v[244:247]
    v_add_f32 v35, v35, v39
    v_add_f32 v40, v40, v44
    v_mfma_f32_16x16x32_bf16 v[200:203], a[140:143], v[144:147], v[200:203]
    v_add_f32 v41, v41, v45
    v_add_f32 v42, v42, v46
    v_mfma_f32_16x16x32_bf16 v[204:207], a[144:147], v[144:147], v[204:207]
    v_add_f32 v43, v43, v47
    v_add_f32 v32, v32, v40
    v_mfma_f32_16x16x32_bf16 v[208:211], a[148:151], v[144:147], v[208:211]
    v_add_f32 v33, v33, v41
    v_add_f32 v34, v34, v42
    v_mfma_f32_16x16x32_bf16 v[212:215], a[152:155], v[144:147], v[212:215]
    v_add_f32 v35, v35, v43
    v_fma_f32 v32, v32, v16, v72
    v_mfma_f32_16x16x32_bf16 v[216:219], a[156:159], v[144:147], v[216:219]
    v_fma_f32 v33, v33, v16, v73
    v_fma_f32 v34, v34, v16, v74
    v_mfma_f32_16x16x32_bf16 v[220:223], a[140:143], v[148:151], v[220:223]
    v_fma_f32 v35, v35, v16, v75
    v_cvt_pk_bf16_f32 v72, v32, v33
    v_mfma_f32_16x16x32_bf16 v[232:235], a[144:147], v[148:151], v[232:235]
    v_cvt_pk_bf16_f32 v73, v34, v35
    s_waitcnt lgkmcnt(8)
    v_mfma_f32_16x16x32_bf16 v[236:239], a[148:151], v[148:151], v[236:239]
    s_waitcnt vmcnt(4)
    v_xor_b32 v188, v11, v188
    v_mfma_f32_16x16x32_bf16 v[240:243], a[152:155], v[148:151], v[240:243]
    v_xor_b32 v191, v12, v191
    v_xor_b32 v104, v11, v104
    v_mfma_f32_16x16x32_bf16 v[244:247], a[156:159], v[148:151], v[244:247]
    v_xor_b32 v107, v12, v107
    v_or3_b32 v21, v188, v191, v104
    v_mfma_f32_16x16x32_bf16 v[200:203], a[160:163], v[152:155], v[200:203]
    v_xor_b32 v108, v11, v108
    v_xor_b32 v111, v12, v111
    v_mfma_f32_16x16x32_bf16 v[204:207], a[164:167], v[152:155], v[204:207]
    v_or3_b32 v21, v21, v107, v108
    v_xor_b32 v112, v11, v112
    v_mfma_f32_16x16x32_bf16 v[208:211], a[168:171], v[152:155], v[208:211]
    v_xor_b32 v115, v12, v115
    v_or3_b32 v21, v21, v111, v112
    v_mfma_f32_16x16x32_bf16 v[212:215], a[172:175], v[152:155], v[212:215]
    v_or_b32 v21, v21, v115
    v_and_b32 v21, 0x80008000, v21
    v_mfma_f32_16x16x32_bf16 v[216:219], a[176:179], v[152:155], v[216:219]
    v_cmp_ne_u32 vcc, 0, v21
    s_cbranch_vccnz L_vsr12
L_vgr12:
    v_mfma_f32_16x16x32_bf16 v[220:223], a[160:163], v[156:159], v[220:223]
    v_add_f32 v48, v48, v52
    v_add_f32 v49, v49, v53
    v_mfma_f32_16x16x32_bf16 v[232:235], a[164:167], v[156:159], v[232:235]
    v_add_f32 v50, v50, v54
    v_add_f32 v51, v51, v55
    v_mfma_f32_16x16x32_bf16 v[236:239], a[168:171], v[156:159], v[236:239]
    v_add_f32 v56, v56, v60
    v_add_f32 v57, v57, v61
    v_mfma_f32_16x16x32_bf16 v[240:243], a[172:175], v[156:159], v[240:243]
    v_add_f32 v58, v58, v62
    v_add_f32 v59, v59, v63
    v_mfma_f32_16x16x32_bf16 v[244:247], a[176:179], v[156:159], v[244:247]
    v_add_f32 v48, v48, v56
    v_add_f32 v49, v49, v57
    v_mfma_f32_16x16x32_bf16 v[200:203], a[180:183], v[188:191], v[200:203]
    v_add_f32 v50, v50, v58
    v_add_f32 v51, v51, v59
    v_mfma_f32_16x16x32_bf16 v[204:207], a[184:187], v[188:191], v[204:207]
    v_fma_f32 v48, v48, v16, v76
    v_fma_f32 v49, v49, v16, v77
    v_mfma_f32_16x16x32_bf16 v[208:211], a[188:191], v[188:191], v[208:211]
    v_fma_f32 v50, v50, v16, v78
    v_fma_f32 v51, v51, v16, v79
    v_mfma_f32_16x16x32_bf16 v[212:215], a[192:195], v[188:191], v[212:215]
    v_cvt_pk_bf16_f32 v74, v48, v49
    v_cvt_pk_bf16_f32 v75, v50, v51
    v_mfma_f32_16x16x32_bf16 v[216:219], a[196:199], v[188:191], v[216:219]
    s_waitcnt lgkmcnt(4)
    v_mfma_f32_16x16x32_bf16 v[220:223], a[180:183], v[104:107], v[220:223]
    buffer_store_dwordx4 v[72:75], v26, s[32:35], s78 offen offset:0
    v_mfma_f32_16x16x32_bf16 v[232:235], a[184:187], v[104:107], v[232:235]
    v_add_f32 v64, v64, v68
    v_add_f32 v65, v65, v69
    v_mfma_f32_16x16x32_bf16 v[236:239], a[188:191], v[104:107], v[236:239]
    s_waitcnt vmcnt(1)
    v_xor_b32 v116, v5, v116
    v_mfma_f32_16x16x32_bf16 v[240:243], a[192:195], v[104:107], v[240:243]
    v_xor_b32 v119, v6, v119
    v_xor_b32 v120, v5, v120
    v_mfma_f32_16x16x32_bf16 v[244:247], a[196:199], v[104:107], v[244:247]
    v_xor_b32 v123, v6, v123
    v_or3_b32 v21, v116, v119, v120
    v_mfma_f32_16x16x32_bf16 v[200:203], a[200:203], v[108:111], v[200:203]
    v_xor_b32 v124, v5, v124
    v_xor_b32 v127, v6, v127
    v_mfma_f32_16x16x32_bf16 v[204:207], a[204:207], v[108:111], v[204:207]
    v_or3_b32 v21, v21, v123, v124
    v_xor_b32 v128, v5, v128
    v_mfma_f32_16x16x32_bf16 v[208:211], a[208:211], v[108:111], v[208:211]
    v_xor_b32 v131, v6, v131
    v_or3_b32 v21, v21, v127, v128
    v_mfma_f32_16x16x32_bf16 v[212:215], a[212:215], v[108:111], v[212:215]
    v_or_b32 v21, v21, v131
    v_and_b32 v21, 0x80008000, v21
    v_mfma_f32_16x16x32_bf16 v[216:219], a[216:219], v[108:111], v[216:219]
    v_cmp_ne_u32 vcc, 0, v21
    s_cbranch_vccnz L_vsr13
L_vgr13:
    v_mfma_f32_16x16x32_bf16 v[220:223], a[200:203], v[112:115], v[220:223]
    v_add_f32 v66, v66, v70
    v_add_f32 v67, v67, v71
    v_mfma_f32_16x16x32_bf16 v[232:235], a[204:207], v[112:115], v[232:235]
    v_add_f32 v192, v192, v196
    v_add_f32 v193, v193, v197
    v_mfma_f32_16x16x32_bf16 v[236:239], a[208:211], v[112:115], v[236:239]
    v_add_f32 v194, v194, v198
    v_add_f32 v195, v195, v199
    v_mfma_f32_16x16x32_bf16 v[240:243], a[212:215], v[112:115], v[240:243]
    v_add_f32 v64, v64, v192
    v_add_f32 v65, v65, v193
    v_mfma_f32_16x16x32_bf16 v[244:247], a[216:219], v[112:115], v[244:247]
    v_add_f32 v66, v66, v194
    v_add_f32 v67, v67, v195
    v_mfma_f32_16x16x32_bf16 v[200:203], a[220:223], v[116:119], v[200:203]
    v_fma_f32 v64, v64, v16, v80
    v_fma_f32 v65, v65, v16, v81
    v_mfma_f32_16x16x32_bf16 v[204:207], a[224:227], v[116:119], v[204:207]
    v_fma_f32 v66, v66, v16, v82
    v_fma_f32 v67, v67, v16, v83
    v_mfma_f32_16x16x32_bf16 v[208:211], a[228:231], v[116:119], v[208:211]
    v_cvt_pk_bf16_f32 v80, v64, v65
    v_cvt_pk_bf16_f32 v81, v66, v67
    v_mfma_f32_16x16x32_bf16 v[212:215], a[232:235], v[116:119], v[212:215]
    s_waitcnt lgkmcnt(0)
    v_add_f32 v224, v224, v228
    v_mfma_f32_16x16x32_bf16 v[216:219], a[236:239], v[116:119], v[216:219]
    v_add_f32 v225, v225, v229
    v_add_f32 v226, v226, v230
    v_mfma_f32_16x16x32_bf16 v[200:203], a[240:243], v[120:123], v[200:203]
    v_add_f32 v227, v227, v231
    v_add_f32 v248, v248, v252
    v_mfma_f32_16x16x32_bf16 v[204:207], a[244:247], v[120:123], v[204:207]
    v_add_f32 v249, v249, v253
    v_add_f32 v250, v250, v254
    v_mfma_f32_16x16x32_bf16 v[208:211], a[248:251], v[120:123], v[208:211]
    v_add_f32 v251, v251, v255
    v_add_f32 v224, v224, v248
    v_mfma_f32_16x16x32_bf16 v[212:215], a[252:255], v[120:123], v[212:215]
    v_add_f32 v225, v225, v249
    v_add_f32 v226, v226, v250
    v_mfma_f32_16x16x32_bf16 v[216:219], a[52:55], v[120:123], v[216:219]
    v_add_f32 v227, v227, v251
    v_fma_f32 v224, v224, v16, v84
    v_mfma_f32_16x16x32_bf16 v[220:223], a[220:223], v[124:127], v[220:223]
    v_fma_f32 v225, v225, v16, v85
    v_fma_f32 v226, v226, v16, v86
    v_mfma_f32_16x16x32_bf16 v[232:235], a[224:227], v[124:127], v[232:235]
    v_fma_f32 v227, v227, v16, v87
    v_cvt_pk_bf16_f32 v82, v224, v225
    v_mfma_f32_16x16x32_bf16 v[236:239], a[228:231], v[124:127], v[236:239]
    v_cvt_pk_bf16_f32 v83, v226, v227
    v_mfma_f32_16x16x32_bf16 v[240:243], a[232:235], v[124:127], v[240:243]
    ds_write_b128 v29, v[200:203] offset:43008
    v_mfma_f32_16x16x32_bf16 v[244:247], a[236:239], v[124:127], v[244:247]
    buffer_store_dwordx4 v[80:83], v26, s[32:35], s78 offen offset:80
    v_mfma_f32_16x16x32_bf16 v[220:223], a[240:243], v[128:131], v[220:223]
    v_mfma_f32_16x16x32_bf16 v[232:235], a[244:247], v[128:131], v[232:235]
    ds_write_b128 v29, v[204:207] offset:43072
    v_mfma_f32_16x16x32_bf16 v[236:239], a[248:251], v[128:131], v[236:239]
    v_mfma_f32_16x16x32_bf16 v[240:243], a[252:255], v[128:131], v[240:243]
    v_mfma_f32_16x16x32_bf16 v[244:247], a[52:55], v[128:131], v[244:247]
    ds_write_b128 v29, v[208:211] offset:43136
    ds_write_b128 v29, v[212:215] offset:43200
    ds_write_b128 v29, v[216:219] offset:43264
    ds_write_b128 v30, v[220:223] offset:43008
    ds_write_b128 v30, v[232:235] offset:43072
    s_nop 0
    ds_write_b128 v30, v[236:239] offset:43136
    ds_write_b128 v30, v[240:243] offset:43200
    ds_write_b128 v30, v[244:247] offset:43264
    s_waitcnt lgkmcnt(0)
    s_barrier
    ds_read_b128 v[32:35], v24 offset:0
    ds_read_b128 v[36:39], v24 offset:10752
    ds_read_b128 v[40:43], v24 offset:21504
    ds_read_b128 v[44:47], v24 offset:32256
    ds_read_b128 v[48:51], v24 offset:16
    ds_read_b128 v[52:55], v24 offset:10768
    ds_read_b128 v[56:59], v24 offset:21520
    ds_read_b128 v[60:63], v24 offset:32272
    ds_read_b128 v[64:67], v24 offset:160
    ds_read_b128 v[68:71], v24 offset:10912
    ds_read_b128 v[192:195], v24 offset:21664
    ds_read_b128 v[196:199], v24 offset:32416
    ds_read_b128 v[224:227], v24 offset:176
    ds_read_b128 v[228:231], v24 offset:10928
    ds_read_b128 v[248:251], v24 offset:21680
    ds_read_b128 v[252:255], v24 offset:32432
    s_waitcnt lgkmcnt(12)
    v_pk_add_f32 v[32:33], v[32:33], v[36:37]
    v_pk_add_f32 v[34:35], v[34:35], v[38:39]
    v_pk_add_f32 v[40:41], v[40:41], v[44:45]
    v_pk_add_f32 v[42:43], v[42:43], v[46:47]
    v_pk_add_f32 v[32:33], v[32:33], v[40:41]
    v_pk_add_f32 v[34:35], v[34:35], v[42:43]
    v_pk_fma_f32 v[32:33], v[32:33], v[16:17], v[88:89] op_sel:[0,1,0] op_sel_hi:[1,1,1]
    v_pk_fma_f32 v[34:35], v[34:35], v[16:17], v[90:91] op_sel:[0,1,0] op_sel_hi:[1,1,1]
    v_cvt_pk_bf16_f32 v88, v32, v33
    v_cvt_pk_bf16_f32 v89, v34, v35
    s_waitcnt lgkmcnt(8)
    v_pk_add_f32 v[48:49], v[48:49], v[52:53]
    v_pk_add_f32 v[50:51], v[50:51], v[54:55]
    v_pk_add_f32 v[56:57], v[56:57], v[60:61]
    v_pk_add_f32 v[58:59], v[58:59], v[62:63]
    v_pk_add_f32 v[48:49], v[48:49], v[56:57]
    v_pk_add_f32 v[50:51], v[50:51], v[58:59]
    v_pk_fma_f32 v[48:49], v[48:49], v[16:17], v[92:93] op_sel:[0,1,0] op_sel_hi:[1,1,1]
    v_pk_fma_f32 v[50:51], v[50:51], v[16:17], v[94:95] op_sel:[0,1,0] op_sel_hi:[1,1,1]
    v_cvt_pk_bf16_f32 v90, v48, v49
    v_cvt_pk_bf16_f32 v91, v50, v51
    buffer_store_dwordx4 v[88:91], v26, s[32:35], s14 offen offset:0
    s_waitcnt lgkmcnt(4)
    v_pk_add_f32 v[64:65], v[64:65], v[68:69]
    v_pk_add_f32 v[66:67], v[66:67], v[70:71]
    v_pk_add_f32 v[192:193], v[192:193], v[196:197]
    v_pk_add_f32 v[194:195], v[194:195], v[198:199]
    v_pk_add_f32 v[64:65], v[64:65], v[192:193]
    v_pk_add_f32 v[66:67], v[66:67], v[194:195]
    v_pk_fma_f32 v[64:65], v[64:65], v[16:17], v[96:97] op_sel:[0,1,0] op_sel_hi:[1,1,1]
    v_pk_fma_f32 v[66:67], v[66:67], v[16:17], v[98:99] op_sel:[0,1,0] op_sel_hi:[1,1,1]
    v_cvt_pk_bf16_f32 v96, v64, v65
    v_cvt_pk_bf16_f32 v97, v66, v67
    s_waitcnt lgkmcnt(0)
    v_pk_add_f32 v[224:225], v[224:225], v[228:229]
    v_pk_add_f32 v[226:227], v[226:227], v[230:231]
    v_pk_add_f32 v[248:249], v[248:249], v[252:253]
    v_pk_add_f32 v[250:251], v[250:251], v[254:255]
    v_pk_add_f32 v[224:225], v[224:225], v[248:249]
    v_pk_add_f32 v[226:227], v[226:227], v[250:251]
    v_pk_fma_f32 v[224:225], v[224:225], v[16:17], v[100:101] op_sel:[0,1,0] op_sel_hi:[1,1,1]
    v_pk_fma_f32 v[226:227], v[226:227], v[16:17], v[102:103] op_sel:[0,1,0] op_sel_hi:[1,1,1]
    v_cvt_pk_bf16_f32 v98, v224, v225
    v_cvt_pk_bf16_f32 v99, v226, v227
    buffer_store_dwordx4 v[96:99], v26, s[32:35], s14 offen offset:80
    s_or_b32 s24, s2, s3
    s_cbranch_scc1 L_noep
    v_mov_b32 v1, s55
    v_mov_b32 v2, 0x4000
    buffer_store_dword v1, v2, s[20:23], 0 offen sc1
L_noep:
L_end:
    s_endpgm
L_joinN:
    s_add_u32 s12, s8, 0
    buffer_load_dwordx4 a[0:3], v3, s[36:39], s12 offen offset:0 sc1
    s_add_u32 s13, s9, 0
    buffer_load_dwordx4 a[4:7], v3, s[36:39], s13 offen offset:0 sc1
    s_add_u32 s18, s10, 0
    buffer_load_dwordx4 a[8:11], v3, s[36:39], s18 offen offset:0 sc1
    s_add_u32 s19, s11, 0
    buffer_load_dwordx4 a[12:15], v3, s[36:39], s19 offen offset:0 sc1
    buffer_load_dwordx4 a[16:19], v3, s[36:39], s12 offen offset:1024 sc1
    buffer_load_dwordx4 a[20:23], v3, s[36:39], s13 offen offset:1024 sc1
    buffer_load_dwordx4 a[24:27], v3, s[36:39], s18 offen offset:1024 sc1
    buffer_load_dwordx4 a[28:31], v3, s[36:39], s19 offen offset:1024 sc1
    s_mov_b32 s28, s14
    s_mov_b32 s29, s15
    s_mov_b32 s30, 0x500
    s_mov_b32 s31, 0x20000
    s_mov_b32 s32, s16
    s_mov_b32 s33, s17
    s_mov_b32 s34, 0x280000
    s_mov_b32 s35, 0x20000
    s_mul_i32 s24, s48, 276480
    s_add_u32 s24, s24, 0x700000
    s_add_u32 s64, s6, s24
    s_addc_u32 s65, s7, 0
    s_mov_b32 s66, 276480
    s_mov_b32 s67, 0x20000
    s_mul_i32 s24, s49, 276480
    s_add_u32 s24, s24, 0x4c0000
    s_add_u32 s60, s6, s24
    s_addc_u32 s61, s7, 0
    s_mov_b32 s62, 276480
    s_mov_b32 s63, 0x20000
    s_mul_i32 s27, s49, 160
    s_mul_i32 s78, s48, 1280
    s_add_u32 s78, s78, s27
    s_sub_u32 s24, 64, s48
    s_cmp_eq_u32 s48, 0
    s_cselect_b32 s24, 32, s24
    s_mul_i32 s14, s24, 1280
    s_add_u32 s14, s14, s27
    v_lshlrev_b32 v197, 2, v0
    buffer_load_dword v131, v197, s[28:31], s27 offen
    s_mul_i32 s76, s3, 5120
    s_mul_i32 s42, s49, 35840
    s_add_u32 s40, s42, s76
    s_lshr_b32 s41, s3, 1
    s_mul_i32 s41, s41, 5120
    s_add_u32 s41, s41, s42
    s_add_u32 s41, s41, 20480
    s_add_u32 s42, s42, 30720
    s_add_u32 s77, s49, 1
    s_and_b32 s77, s77, 7
    s_mul_i32 s77, s77, 35840
    s_add_u32 s4, s77, s76
    s_add_u32 s77, s49, 2
    s_and_b32 s77, s77, 7
    s_mul_i32 s77, s77, 35840
    s_add_u32 s5, s77, s76
    s_add_u32 s77, s49, 3
    s_and_b32 s77, s77, 7
    s_mul_i32 s77, s77, 35840
    s_add_u32 s15, s77, s76
    s_add_u32 s77, s49, 4
    s_and_b32 s77, s77, 7
    s_mul_i32 s77, s77, 35840
    s_add_u32 s16, s77, s76
    s_add_u32 s77, s49, 5
    s_and_b32 s77, s77, 7
    s_mul_i32 s77, s77, 35840
    s_add_u32 s17, s77, s76
    s_add_u32 s77, s49, 6
    s_and_b32 s77, s77, 7
    s_mul_i32 s77, s77, 35840
    s_add_u32 s43, s77, s76
    s_add_u32 s77, s49, 7
    s_and_b32 s77, s77, 7
    s_mul_i32 s77, s77, 35840
    s_add_u32 s56, s77, s76
    s_mul_i32 s76, s3, 71680
    s_add_u32 s57, s76, 20480
    s_add_u32 s58, s76, 56320
    s_add_u32 s59, s76, 25600
    s_add_u32 s73, s76, 30720
    s_add_u32 s74, s76, 61440
    s_add_u32 s75, s76, 66560
    buffer_load_dword v151, v154, s[20:23], s79 offen offset:512 sc1
    buffer_load_dwordx4 a[32:35], v3, s[36:39], s12 offen offset:2048 sc1
    buffer_load_dwordx4 a[36:39], v3, s[36:39], s13 offen offset:2048 sc1
    buffer_load_dwordx4 a[40:43], v3, s[36:39], s18 offen offset:2048 sc1
    buffer_load_dwordx4 a[44:47], v3, s[36:39], s19 offen offset:2048 sc1
    buffer_load_dwordx4 a[48:51], v3, s[36:39], s12 offen offset:3072 sc1
    buffer_load_dwordx4 a[52:55], v3, s[36:39], s13 offen offset:3072 sc1
    buffer_load_dwordx4 a[56:59], v3, s[36:39], s18 offen offset:3072 sc1
    buffer_load_dwordx4 a[60:63], v3, s[36:39], s19 offen offset:3072 sc1
    s_add_u32 s12, s8, 4096
    buffer_load_dwordx4 a[64:67], v3, s[36:39], s12 offen offset:0 sc1
    s_add_u32 s13, s9, 4096
    buffer_load_dwordx4 a[68:71], v3, s[36:39], s13 offen offset:0 sc1
    s_waitcnt vmcnt(10)
    s_barrier
    s_lshr_b32 s24, s54, 15
    s_or_b32 s24, s24, s3
    s_cbranch_scc1 L_pf
    v_and_b32 v240, 7, v0
    v_lshlrev_b32 v240, 11, v240
    v_mov_b32 v241, s55
    s_and_b32 s24, s54, 0xfffc
    buffer_store_dword v241, v240, s[20:23], s24 offen sc1
L_pf:
    s_mov_b32 s45, 0
L_gcP:
    v_cmp_ne_u32 vcc, s55, v151
    s_nop 1
    s_or_b32 s47, vcc_lo, vcc_hi
    s_cbranch_scc0 L_ggP
    s_add_u32 s45, s45, 1
    s_cmp_ge_u32 s45, 0x40000
    s_cbranch_scc1 L_ggP
    s_sleep 4
    buffer_load_dword v151, v154, s[20:23], s79 offen offset:512 sc1
    s_waitcnt vmcnt(0)
    s_branch L_gcP
L_ggP:
    s_cmp_eq_u32 s45, 0
    s_cbranch_scc1 L_gbP
    s_sleep 11
L_gbP:
    global_load_dword v32, v10, s[6:7] offset:-2048 sc1
    global_load_dword v33, v10, s[6:7] offset:-768 sc1
    global_load_dword v34, v10, s[6:7] offset:512 sc1
    global_load_dword v35, v10, s[6:7] offset:1792 sc1
    global_load_dword v36, v11, s[6:7] offset:-2048 sc1
    global_load_dword v37, v11, s[6:7] offset:-768 sc1
    global_load_dword v38, v11, s[6:7] offset:512 sc1
    global_load_dword v39, v11, s[6:7] offset:1792 sc1
    global_load_dword v40, v12, s[6:7] offset:-2048 sc1
    global_load_dword v41, v12, s[6:7] offset:-768 sc1
    global_load_dword v42, v12, s[6:7] offset:512 sc1
    global_load_dword v43, v12, s[6:7] offset:1792 sc1
    global_load_dword v44, v13, s[6:7] offset:-2048 sc1
    global_load_dword v45, v13, s[6:7] offset:-768 sc1
    global_load_dword v46, v13, s[6:7] offset:512 sc1
    global_load_dword v47, v13, s[6:7] offset:1792 sc1
    global_load_dword v48, v10, s[6:7] offset:-1920 sc1
    global_load_dword v49, v10, s[6:7] offset:-640 sc1
    global_load_dword v50, v10, s[6:7] offset:640 sc1
    global_load_dword v51, v10, s[6:7] offset:1920 sc1
    global_load_dword v52, v11, s[6:7] offset:-1920 sc1
    global_load_dword v53, v11, s[6:7] offset:-640 sc1
    global_load_dword v54, v11, s[6:7] offset:640 sc1
    global_load_dword v55, v11, s[6:7] offset:1920 sc1
    global_load_dword v56, v12, s[6:7] offset:-1920 sc1
    global_load_dword v57, v12, s[6:7] offset:-640 sc1
    global_load_dword v58, v12, s[6:7] offset:640 sc1
    global_load_dword v59, v12, s[6:7] offset:1920 sc1
    global_load_dword v60, v13, s[6:7] offset:-1920 sc1
    global_load_dword v61, v13, s[6:7] offset:-640 sc1
    global_load_dword v62, v13, s[6:7] offset:640 sc1
    global_load_dword v63, v13, s[6:7] offset:1920 sc1
    global_load_dword v64, v10, s[6:7] offset:-1792 sc1
    global_load_dword v65, v10, s[6:7] offset:-512 sc1
    global_load_dword v66, v10, s[6:7] offset:768 sc1
    global_load_dword v67, v10, s[6:7] offset:2048 sc1
    global_load_dword v68, v11, s[6:7] offset:-1792 sc1
    global_load_dword v69, v11, s[6:7] offset:-512 sc1
    global_load_dword v70, v11, s[6:7] offset:768 sc1
    global_load_dword v71, v11, s[6:7] offset:2048 sc1
    global_load_dword v72, v12, s[6:7] offset:-1792 sc1
    global_load_dword v73, v12, s[6:7] offset:-512 sc1
    global_load_dword v74, v12, s[6:7] offset:768 sc1
    global_load_dword v75, v12, s[6:7] offset:2048 sc1
    global_load_dword v76, v13, s[6:7] offset:-1792 sc1
    global_load_dword v77, v13, s[6:7] offset:-512 sc1
    global_load_dword v78, v13, s[6:7] offset:768 sc1
    global_load_dword v79, v13, s[6:7] offset:2048 sc1
    s_branch L_join2
L1_relayout:
    s_sub_u32 s19, s2, 168
    s_add_u32 s24, s2, 88
    s_cmp_lt_u32 s2, 8
    s_cselect_b32 s19, s24, s19
    s_cmp_ge_u32 s19, 54
    s_cbranch_scc1 L1_w2
    s_lshr_b32 s38, s19, 1
    s_and_b32 s39, s19, 1
    s_mul_i32 s40, s39, 320
    s_mul_i32 s41, s3, 80
    s_add_u32 s40, s40, s41
    s_add_u32 s41, s40, s39
    v_lshrrev_b32 v33, 3, v0
    v_add_u32 v34, s41, v33
    v_add_u32 v35, 72, v34
    v_mov_b32 v36, 320
    v_cmp_eq_u32 vcc, 640, v35
    s_nop 1
    v_cndmask_b32 v35, v35, v36, vcc
    v_and_b32 v36, 7, v0
    v_lshlrev_b32 v36, 4, v36
    s_lshl_b32 s42, s38, 7
    v_add_u32 v36, s42, v36
    s_movk_i32 s43, 3456
    v_mad_u32_u24 v34, v34, s43, v36
    v_mad_u32_u24 v35, v35, s43, v36
    s_lshl_b32 s24, s3, 14
    s_waitcnt lgkmcnt(0)
    s_mov_b32 s56, s4
    s_mov_b32 s57, s5
    s_mov_b32 s58, 0x280000
    s_mov_b32 s59, 0x20000
    s_add_u32 s46, s6, 0x6e4000
    s_addc_u32 s47, s7, 0
    s_load_dword s55, s[46:47], 0
    s_mov_b32 s64, s8
    s_mov_b32 s65, s9
    s_mov_b32 s66, 0x21c000
    s_mov_b32 s67, 0x20000
    s_add_u32 m0, s24, 0
    s_mov_b32 s25, 0
    buffer_load_dwordx4 v34, s[64:67], s25 offen nt lds
    s_add_u32 m0, s24, 1024
    s_mov_b32 s25, 27648
    buffer_load_dwordx4 v34, s[64:67], s25 offen nt lds
    s_add_u32 m0, s24, 2048
    s_mov_b32 s25, 55296
    buffer_load_dwordx4 v34, s[64:67], s25 offen nt lds
    s_add_u32 m0, s24, 3072
    s_mov_b32 s25, 82944
    buffer_load_dwordx4 v34, s[64:67], s25 offen nt lds
    s_add_u32 m0, s24, 4096
    s_mov_b32 s25, 110592
    buffer_load_dwordx4 v34, s[64:67], s25 offen nt lds
    s_add_u32 m0, s24, 5120
    s_mov_b32 s25, 138240
    buffer_load_dwordx4 v34, s[64:67], s25 offen nt lds
    s_add_u32 m0, s24, 6144
    s_mov_b32 s25, 165888
    buffer_load_dwordx4 v34, s[64:67], s25 offen nt lds
    s_add_u32 m0, s24, 7168
    s_mov_b32 s25, 193536
    buffer_load_dwordx4 v34, s[64:67], s25 offen nt lds
    s_add_u32 m0, s24, 8192
    s_mov_b32 s25, 221184
    buffer_load_dwordx4 v34, s[64:67], s25 offen nt lds
    s_add_u32 m0, s24, 9216
    s_nop 0
    buffer_load_dwordx4 v35, s[64:67], 0 offen nt lds
    s_add_u32 s28, s6, 0x280000
    s_addc_u32 s29, s7, 0
    s_mov_b32 s30, 0x237000
    s_mov_b32 s31, 0x20000
    s_mov_b32 s32, s10
    s_mov_b32 s33, s11
    s_mov_b32 s34, 0xd80
    s_mov_b32 s35, 0x20000
    s_lshl_b32 s25, s38, 1
    s_mul_i32 s26, s25, 9363
    s_lshr_b32 s26, s26, 16
    s_mul_i32 s26, s26, 7
    s_sub_u32 s25, s25, s26
    s_cmp_lt_u32 s25, 4
    s_cselect_b32 s60, -1, 0
    s_lshl_b32 s25, s38, 1
    s_add_u32 s25, s25, 1
    s_mul_i32 s26, s25, 9363
    s_lshr_b32 s26, s26, 16
    s_mul_i32 s26, s26, 7
    s_sub_u32 s25, s25, s26
    s_cmp_lt_u32 s25, 4
    s_cselect_b32 s61, -1, 0
    v_bfe_u32 v86, v0, 4, 1
    v_bfe_u32 v87, v0, 2, 2
    v_lshlrev_b32 v84, 2, v86
    v_lshl_add_u32 v84, v87, 3, v84
    v_lshlrev_b32 v85, 4, v86
    v_bfe_u32 v87, v0, 2, 1
    v_lshl_add_u32 v85, v87, 3, v85
    v_bfe_u32 v87, v0, 3, 1
    v_lshl_add_u32 v85, v87, 2, v85
    v_cndmask_b32 v42, v85, v84, s[60:61]
    v_and_b32 v36, 35, v0
    v_add_lshl_u32 v42, v42, v36, 1
    buffer_load_ushort v43, v42, s[32:35], s42 offen
    v_bfe_u32 v86, v0, 4, 1
    v_bfe_u32 v87, v0, 0, 2
    v_lshlrev_b32 v84, 2, v86
    v_lshl_add_u32 v84, v87, 3, v84
    v_lshlrev_b32 v85, 4, v86
    v_bfe_u32 v87, v0, 0, 1
    v_lshl_add_u32 v85, v87, 3, v85
    v_bfe_u32 v87, v0, 1, 1
    v_lshl_add_u32 v85, v87, 2, v85
    v_bfe_u32 v33, v0, 2, 2
    v_lshrrev_b32 v36, 5, v0
    v_lshl_add_u32 v33, v36, 3, v33
    v_lshlrev_b32 v33, 7, v33
    v_add_u32 v33, s24, v33
    s_mov_b32 s62, s60
    s_mov_b32 s63, s60
    s_mov_b32 s60, s61
    v_cndmask_b32 v86, v85, v84, s[62:63]
    v_cndmask_b32 v87, v85, v84, s[60:61]
    v_lshl_add_u32 v86, v86, 1, v33
    v_lshl_add_u32 v87, v87, 1, v33
    v_bfe_u32 v37, v0, 4, 1
    v_mul_u32_u24 v37, 21504, v37
    v_and_b32 v39, 15, v0
    v_lshl_add_u32 v88, v39, 4, v37
    v_lshl_add_u32 v37, v36, 8, v88
    v_mov_b32 v38, 0x3f803f80
    v_mov_b32 v40, 0
    v_mov_b32 v41, 0
    s_lshl_b32 s27, s38, 1
    v_lshrrev_b32 v89, 3, v0
    v_and_b32 v89, 1, v89
    v_add_u32 v89, s27, v89
    v_mul_u32_u24 v89, 9363, v89
    v_lshrrev_b32 v89, 16, v89
    v_mul_u32_u24 v90, 7, v89
    v_lshrrev_b32 v90, 1, v90
    v_sub_u32 v90, s38, v90
    v_lshl_add_u32 v90, v90, 1, s39
    v_lshlrev_b32 v90, 2, v90
    v_lshl_add_u32 v90, v89, 10, v90
    v_and_b32 v89, 7, v0
    v_lshl_add_u32 v90, v89, 13, v90
    v_add_u32 v90, 0x8000, v90
    s_mul_i32 s26, s38, 86016
    s_add_u32 s36, s26, 20480
    s_lshl_b32 s27, s40, 5
    s_add_u32 s26, s26, s27
    s_mov_b32 s47, s24
    s_and_b32 s44, s2, 7
    s_lshr_b32 s45, s2, 3
    s_lshl_b32 s48, s44, 2
    s_lshr_b32 s24, s45, 3
    s_add_u32 s48, s48, s24
    s_and_b32 s49, s45, 7
    s_lshr_b32 s24, s48, 1
    s_sub_u32 s25, 32, s24
    s_cmp_eq_u32 s48, 1
    s_cselect_b32 s25, 16, s25
    s_and_b32 s48, s48, 1
    s_cselect_b32 s48, s25, s24
    s_sub_u32 s24, 64, s48
    s_cmp_eq_u32 s48, 0
    s_cselect_b32 s24, 32, s24
    s_cmp_lt_u32 s3, 2
    s_cselect_b32 s50, s48, s24
    s_and_b32 s51, s3, 1
    s_lshl_b32 s52, s51, 10
    s_add_u32 s52, s52, s50
    s_mul_i32 s52, s52, 1280
    s_lshl_b32 s53, s3, 10
    v_lshrrev_b32 v241, 2, v0
    v_lshrrev_b32 v242, 3, v0
    v_and_b32 v242, 6, v242
    s_movk_i32 s24, 0x78
    v_lshrrev_b32 v242, v242, s24
    v_xor_b32 v242, v242, v0
    v_and_b32 v242, 3, v242
    v_lshlrev_b32 v242, 4, v242
    s_mov_b32 s24, 81920
    v_mad_u32_u24 v243, v241, s24, v242
    s_mov_b32 s24, s47
    v_lshlrev_b32 v3, 4, v0
    v_lshrrev_b32 v1, 5, v0
    v_and_b32 v2, 31, v0
    v_and_b32 v207, 3, v0
    v_bfe_u32 v193, v0, 2, 1
    v_lshl_add_u32 v207, v193, 4, v207
    v_bfe_u32 v193, v0, 3, 2
    v_lshl_add_u32 v207, v193, 2, v207
    v_mul_u32_u24 v10, 5120, v1
    v_lshl_add_u32 v10, v207, 2, v10
    s_mul_i32 s45, s50, 40960
    s_mul_i32 s44, s51, 640
    s_add_u32 s45, s45, s44
    s_add_u32 s45, s45, 2048
    v_add_u32 v10, s45, v10
    v_add_u32 v11, 10240, v10
    v_add_u32 v12, 20480, v10
    v_add_u32 v13, 30720, v10
    v_cvt_f32_u32 v192, v2
    v_mul_f32 v192, 0x3d000000, v192
    v_cvt_f32_u32 v193, v1
    v_mul_f32 v193, 4.0, v193
    v_add_f32 v194, 0x00000000, v193
    v_mul_f32 v194, v194, v192
    v_add_f32 v195, v194, v192
    v_cos_f32 v196, v194
    v_sin_f32 v197, v194
    v_cos_f32 v198, v195
    v_sin_f32 v199, v195
    v_cvt_pk_f16_f32 v160, v196, v197
    v_cvt_pk_f16_f32 v161, v198, v199
    v_add_f32 v194, 0x40000000, v193
    v_mul_f32 v194, v194, v192
    v_add_f32 v195, v194, v192
    v_cos_f32 v196, v194
    v_sin_f32 v197, v194
    v_cos_f32 v198, v195
    v_sin_f32 v199, v195
    v_cvt_pk_f16_f32 v162, v196, v197
    v_cvt_pk_f16_f32 v163, v198, v199
    v_add_f32 v194, 0x41000000, v193
    v_mul_f32 v194, v194, v192
    v_add_f32 v195, v194, v192
    v_cos_f32 v196, v194
    v_sin_f32 v197, v194
    v_cos_f32 v198, v195
    v_sin_f32 v199, v195
    v_cvt_pk_f16_f32 v164, v196, v197
    v_cvt_pk_f16_f32 v165, v198, v199
    v_add_f32 v194, 0x41200000, v193
    v_mul_f32 v194, v194, v192
    v_add_f32 v195, v194, v192
    v_cos_f32 v196, v194
    v_sin_f32 v197, v194
    v_cos_f32 v198, v195
    v_sin_f32 v199, v195
    v_cvt_pk_f16_f32 v166, v196, v197
    v_cvt_pk_f16_f32 v167, v198, v199
    v_add_f32 v194, 0x41800000, v193
    v_mul_f32 v194, v194, v192
    v_add_f32 v195, v194, v192
    v_cos_f32 v196, v194
    v_sin_f32 v197, v194
    v_cos_f32 v198, v195
    v_sin_f32 v199, v195
    v_cvt_pk_f16_f32 v168, v196, v197
    v_cvt_pk_f16_f32 v169, v198, v199
    v_add_f32 v194, 0x41900000, v193
    v_mul_f32 v194, v194, v192
    v_add_f32 v195, v194, v192
    v_cos_f32 v196, v194
    v_sin_f32 v197, v194
    v_cos_f32 v198, v195
    v_sin_f32 v199, v195
    v_cvt_pk_f16_f32 v170, v196, v197
    v_cvt_pk_f16_f32 v171, v198, v199
    v_add_f32 v194, 0x41c00000, v193
    v_mul_f32 v194, v194, v192
    v_add_f32 v195, v194, v192
    v_cos_f32 v196, v194
    v_sin_f32 v197, v194
    v_cos_f32 v198, v195
    v_sin_f32 v199, v195
    v_cvt_pk_f16_f32 v172, v196, v197
    v_cvt_pk_f16_f32 v173, v198, v199
    v_add_f32 v194, 0x41d00000, v193
    v_mul_f32 v194, v194, v192
    v_add_f32 v195, v194, v192
    v_cos_f32 v196, v194
    v_sin_f32 v197, v194
    v_cos_f32 v198, v195
    v_sin_f32 v199, v195
    v_cvt_pk_f16_f32 v174, v196, v197
    v_cvt_pk_f16_f32 v175, v198, v199
    v_lshlrev_b32 v195, 2, v1
    v_and_b32 v192, 1, v207
    v_lshlrev_b32 v192, 4, v192
    v_mov_b32 v193, 0x3f80
    v_lshlrev_b32 v192, v192, v193
    v_lshrrev_b32 v193, 1, v207
    v_sub_u32 v193, v193, v195
    v_cmp_eq_u32 s[46:47], 0, v193
    v_cmp_eq_u32 vcc, 1, v193
    s_nop 0
    v_cndmask_b32 v176, 0, v192, s[46:47]
    v_cndmask_b32 v177, 0, v192, vcc
    v_cmp_eq_u32 s[46:47], 2, v193
    v_cmp_eq_u32 vcc, 3, v193
    s_nop 0
    v_cndmask_b32 v178, 0, v192, s[46:47]
    v_cndmask_b32 v179, 0, v192, vcc
    v_cmp_eq_u32 s[46:47], 8, v193
    v_cmp_eq_u32 vcc, 9, v193
    s_nop 0
    v_cndmask_b32 v180, 0, v192, s[46:47]
    v_cndmask_b32 v181, 0, v192, vcc
    v_cmp_eq_u32 s[46:47], 10, v193
    v_cmp_eq_u32 vcc, 11, v193
    s_nop 0
    v_cndmask_b32 v182, 0, v192, s[46:47]
    v_cndmask_b32 v183, 0, v192, vcc
    v_sub_u32 v196, 32, v207
    v_and_b32 v192, 1, v196
    v_lshlrev_b32 v192, 4, v192
    v_mov_b32 v193, 0x3f80
    v_lshlrev_b32 v192, v192, v193
    v_lshrrev_b32 v193, 1, v196
    v_sub_u32 v193, v193, v195
    v_cmp_eq_u32 s[46:47], 0, v193
    v_cmp_eq_u32 vcc, 1, v193
    s_nop 0
    v_cndmask_b32 v184, 0, v192, s[46:47]
    v_cndmask_b32 v185, 0, v192, vcc
    v_cmp_eq_u32 s[46:47], 2, v193
    v_cmp_eq_u32 vcc, 3, v193
    s_nop 0
    v_cndmask_b32 v186, 0, v192, s[46:47]
    v_cndmask_b32 v187, 0, v192, vcc
    v_cmp_eq_u32 s[46:47], 8, v193
    v_cmp_eq_u32 vcc, 9, v193
    s_nop 0
    v_cndmask_b32 v188, 0, v192, s[46:47]
    v_cndmask_b32 v189, 0, v192, vcc
    v_cmp_eq_u32 s[46:47], 10, v193
    v_cmp_eq_u32 vcc, 11, v193
    s_nop 0
    v_cndmask_b32 v190, 0, v192, s[46:47]
    v_cndmask_b32 v191, 0, v192, vcc
    v_add_u32 v4, 4096, v3
    s_lshr_b32 s45, s3, 1
    s_lshl_b32 s45, s45, 5
    v_add_u32 v192, s45, v2
    v_lshlrev_b32 v193, 6, v2
    v_add_u32 v193, s50, v193
    v_sub_u32 v193, 2048, v193
    v_and_b32 v194, 63, v193
    v_bfe_u32 v193, v193, 6, 5
    v_cmp_ne_u32 s[46:47], s48, v194
    s_nop 1
    v_cndmask_b32 v194, 0, 32, s[46:47]
    v_add_u32 v193, v193, v194
    v_lshrrev_b32 v194, 1, v192
    v_and_b32 v194, 6, v194
    s_movk_i32 s44, 0x78
    v_bfe_u32 v194, s44, v194, 2
    v_lshlrev_b32 v194, 4, v194
    v_lshl_add_u32 v194, v192, 6, v194
    s_mul_i32 s44, s51, 20480
    s_add_u32 s45, s44, 122880
    v_add_u32 v194, s45, v194
    v_lshrrev_b32 v196, 1, v193
    v_and_b32 v196, 6, v196
    s_movk_i32 s44, 0x78
    v_bfe_u32 v196, s44, v196, 2
    v_lshlrev_b32 v196, 4, v196
    v_lshl_add_u32 v196, v193, 6, v196
    s_mul_i32 s44, s51, 20480
    s_sub_u32 s44, 61440, s44
    v_add_u32 v196, s44, v196
    v_lshlrev_b32 v197, 4, v1
    v_lshlrev_b32 v198, 5, v1
    v_xor_b32 v14, v194, v198
    v_xor_b32 v15, 16, v14
    v_xor_b32 v16, v196, v198
    v_xor_b32 v16, 32, v16
    v_xor_b32 v17, 16, v16
    v_xor_b32 v18, v194, v197
    v_xor_b32 v19, 32, v18
    v_xor_b32 v20, v196, v197
    v_xor_b32 v21, 32, v20
    v_add_u32 v22, 4096, v196
    s_cmp_eq_u32 s51, 0
    s_cselect_b32 s44, 40960, 0
    v_subrev_u32 v23, s44, v22
    v_or_b32 v197, s51, v1
    v_cmp_eq_u32 s[46:47], 0, v197
    s_nop 1
    v_cndmask_b32 v24, 0, -1.0, s[46:47]
    v_cvt_f32_u32 v25, v1
    v_sub_f32 v25, 1.0, v25
    v_lshrrev_b32 v194, 1, v0
    v_and_b32 v194, 6, v194
    s_movk_i32 s44, 0x78
    v_bfe_u32 v194, s44, v194, 2
    v_lshrrev_b32 v195, 4, v0
    v_xor_b32 v194, v194, v195
    v_lshlrev_b32 v194, 4, v194
    v_and_b32 v195, 15, v0
    v_lshl_add_u32 v194, v195, 6, v194
    s_mul_i32 s44, s51, -80896
    s_add_u32 s44, s44, 122880
    v_add_u32 v5, s44, v194
    v_xor_b32 v6, 1024, v5
    s_mul_i32 s44, s51, 82944
    s_add_u32 s44, s44, 40960
    v_add_u32 v7, s44, v194
    v_xor_b32 v8, 1024, v7
    v_mov_b32 v128, 0
    v_mov_b32 v148, 0
    v_mov_b32 v26, 0
    v_mov_b32 v27, 0
    v_mov_b32 v28, 0
    v_mov_b32 v29, 0
    v_mov_b32 v152, 0x3f803f80
    s_lshl_b32 s44, s51, 4
    s_add_u32 s44, s44, 22016
    v_lshl_add_u32 v197, v1, 3, s44
    v_lshl_add_u32 v30, v192, 6, v197
    v_lshl_add_u32 v31, v193, 6, v197
    s_waitcnt lgkmcnt(0)
    s_mul_i32 s55, s55, 0x9e3779b1
    s_add_u32 s55, s55, 0x7f4a7c15
    s_add_u32 s20, s6, 0x6e0000
    s_addc_u32 s21, s7, 0
    s_mov_b32 s22, 0x18000
    s_mov_b32 s23, 0x20000
    v_and_b32 v193, 15, v207
    v_lshlrev_b32 v193, 1, v193
    v_lshrrev_b32 v193, v193, s55
    v_and_b32 v9, 1, v193
    v_bfe_u32 v193, v193, 1, 1
    v_lshl_or_b32 v9, v193, 16, v9
    s_waitcnt vmcnt(9)
    ds_read_b64_tr_b16 v[44:45], v86 offset:0
    ds_read_b64_tr_b16 v[46:47], v86 offset:512
    ds_read_b64_tr_b16 v[48:49], v87 offset:64
    ds_read_b64_tr_b16 v[50:51], v87 offset:576
    s_waitcnt lgkmcnt(2)
    s_add_u32 s27, s26, 0
    buffer_store_dwordx4 v[44:47], v37, s[28:31], s27 offen sc1
    v_dot2c_f32_bf16 v40, v44, v38
    v_dot2c_f32_bf16 v40, v45, v38
    v_dot2c_f32_bf16 v40, v46, v38
    v_dot2c_f32_bf16 v40, v47, v38
    s_waitcnt lgkmcnt(0)
    s_add_u32 s27, s26, 43008
    buffer_store_dwordx4 v[48:51], v37, s[28:31], s27 offen sc1
    v_dot2c_f32_bf16 v41, v48, v38
    v_dot2c_f32_bf16 v41, v49, v38
    v_dot2c_f32_bf16 v41, v50, v38
    v_dot2c_f32_bf16 v41, v51, v38
    s_waitcnt vmcnt(9)
    ds_read_b64_tr_b16 v[52:53], v86 offset:2048
    ds_read_b64_tr_b16 v[54:55], v86 offset:2560
    ds_read_b64_tr_b16 v[56:57], v87 offset:2112
    ds_read_b64_tr_b16 v[58:59], v87 offset:2624
    s_waitcnt lgkmcnt(2)
    s_add_u32 s27, s26, 512
    buffer_store_dwordx4 v[52:55], v37, s[28:31], s27 offen sc1
    v_dot2c_f32_bf16 v40, v52, v38
    v_dot2c_f32_bf16 v40, v53, v38
    v_dot2c_f32_bf16 v40, v54, v38
    v_dot2c_f32_bf16 v40, v55, v38
    s_waitcnt lgkmcnt(0)
    s_add_u32 s27, s26, 43520
    buffer_store_dwordx4 v[56:59], v37, s[28:31], s27 offen sc1
    v_dot2c_f32_bf16 v41, v56, v38
    v_dot2c_f32_bf16 v41, v57, v38
    v_dot2c_f32_bf16 v41, v58, v38
    v_dot2c_f32_bf16 v41, v59, v38
    s_waitcnt vmcnt(9)
    ds_read_b64_tr_b16 v[60:61], v86 offset:4096
    ds_read_b64_tr_b16 v[62:63], v86 offset:4608
    ds_read_b64_tr_b16 v[64:65], v87 offset:4160
    ds_read_b64_tr_b16 v[66:67], v87 offset:4672
    s_waitcnt lgkmcnt(2)
    s_add_u32 s27, s26, 1024
    buffer_store_dwordx4 v[60:63], v37, s[28:31], s27 offen sc1
    v_dot2c_f32_bf16 v40, v60, v38
    v_dot2c_f32_bf16 v40, v61, v38
    v_dot2c_f32_bf16 v40, v62, v38
    v_dot2c_f32_bf16 v40, v63, v38
    s_waitcnt lgkmcnt(0)
    s_add_u32 s27, s26, 44032
    buffer_store_dwordx4 v[64:67], v37, s[28:31], s27 offen sc1
    v_dot2c_f32_bf16 v41, v64, v38
    v_dot2c_f32_bf16 v41, v65, v38
    v_dot2c_f32_bf16 v41, v66, v38
    v_dot2c_f32_bf16 v41, v67, v38
    s_waitcnt vmcnt(9)
    ds_read_b64_tr_b16 v[68:69], v86 offset:6144
    ds_read_b64_tr_b16 v[70:71], v86 offset:6656
    ds_read_b64_tr_b16 v[72:73], v87 offset:6208
    ds_read_b64_tr_b16 v[74:75], v87 offset:6720
    s_waitcnt lgkmcnt(2)
    s_add_u32 s27, s26, 1536
    buffer_store_dwordx4 v[68:71], v37, s[28:31], s27 offen sc1
    v_dot2c_f32_bf16 v40, v68, v38
    v_dot2c_f32_bf16 v40, v69, v38
    v_dot2c_f32_bf16 v40, v70, v38
    v_dot2c_f32_bf16 v40, v71, v38
    s_waitcnt lgkmcnt(0)
    s_add_u32 s27, s26, 44544
    buffer_store_dwordx4 v[72:75], v37, s[28:31], s27 offen sc1
    v_dot2c_f32_bf16 v41, v72, v38
    v_dot2c_f32_bf16 v41, v73, v38
    v_dot2c_f32_bf16 v41, v74, v38
    v_dot2c_f32_bf16 v41, v75, v38
    s_waitcnt vmcnt(9)
    ds_read_b64_tr_b16 v[76:77], v86 offset:8192
    ds_read_b64_tr_b16 v[78:79], v86 offset:8704
    ds_read_b64_tr_b16 v[80:81], v87 offset:8256
    ds_read_b64_tr_b16 v[82:83], v87 offset:8768
    s_waitcnt lgkmcnt(2)
    s_add_u32 s27, s26, 2048
    buffer_store_dwordx4 v[76:79], v37, s[28:31], s27 offen sc1
    v_dot2c_f32_bf16 v40, v76, v38
    v_dot2c_f32_bf16 v40, v77, v38
    v_dot2c_f32_bf16 v40, v78, v38
    v_dot2c_f32_bf16 v40, v79, v38
    s_waitcnt lgkmcnt(0)
    s_add_u32 s27, s26, 45056
    buffer_store_dwordx4 v[80:83], v37, s[28:31], s27 offen sc1
    v_dot2c_f32_bf16 v41, v80, v38
    v_dot2c_f32_bf16 v41, v81, v38
    v_dot2c_f32_bf16 v41, v82, v38
    v_dot2c_f32_bf16 v41, v83, v38
    s_nop 2
    v_permlane32_swap_b32 v40, v41
    v_add_f32 v40, v40, v41
    s_lshl_b32 s27, s3, 8
    v_lshlrev_b32 v36, 2, v0
    v_add_u32 v39, s27, v36
    ds_write_b32 v39, v40 offset:64512
    s_waitcnt lgkmcnt(0)
    s_barrier
    s_cmp_lg_u32 s3, 0
    s_cbranch_scc1 L1_w1_done
    ds_read_b32 v44, v36 offset:64512
    ds_read_b32 v45, v36 offset:64768
    ds_read_b32 v46, v36 offset:65024
    ds_read_b32 v47, v36 offset:65280
    v_lshrrev_b32 v33, 5, v0
    v_mul_u32_u24 v33, 43008, v33
    v_add_u32 v33, v33, v88
    s_lshl_b32 s25, s39, 8
    s_add_u32 s27, s36, s25
    s_cmp_eq_u32 s39, 0
    s_cselect_b32 s25, 0xffff, 0
    s_waitcnt vmcnt(10) lgkmcnt(0)
    v_and_b32 v50, s25, v43
    v_add_f32 v44, v44, v45
    v_add_f32 v46, v46, v47
    v_add_f32 v44, v44, v46
    v_cvt_pk_bf16_f32 v48, v44, v44
    v_and_b32 v45, 0xffff0000, v48
    v_sub_f32 v44, v44, v45
    v_cvt_pk_bf16_f32 v49, v44, v44
    v_and_b32 v49, 0xffff, v49
    v_lshl_or_b32 v49, v50, 16, v49
    v_mov_b32 v51, 0
    buffer_store_dwordx4 v[48:51], v33, s[28:31], s27 offen sc1
L1_w1_done:
    v_mov_b32 v33, s55
    s_waitcnt vmcnt(0)
    s_barrier
    s_cmp_lg_u32 s3, 0
    s_cbranch_scc1 L1_pf1
    buffer_store_dword v33, v90, s[20:23], 0 offen sc1
L1_pf1:
    s_mov_b32 s54, 0x8001
    s_add_u32 m0, s53, 122880
    s_nop 0
    buffer_load_dwordx4 v243, s[56:59], s52 offen offset:0 lds
    s_add_u32 m0, s53, 126912
    s_nop 0
    buffer_load_dwordx4 v243, s[56:59], s52 offen offset:64 lds
    s_add_u32 m0, s53, 130944
    s_nop 0
    buffer_load_dwordx4 v243, s[56:59], s52 offen offset:128 lds
    s_add_u32 m0, s53, 134976
    s_nop 0
    buffer_load_dwordx4 v243, s[56:59], s52 offen offset:192 lds
    s_add_u32 m0, s53, 139008
    s_nop 0
    buffer_load_dwordx4 v243, s[56:59], s52 offen offset:256 lds
    s_add_u32 m0, s53, 143040
    s_nop 0
    buffer_load_dwordx4 v243, s[56:59], s52 offen offset:320 lds
    s_add_u32 m0, s53, 147072
    s_nop 0
    buffer_load_dwordx4 v243, s[56:59], s52 offen offset:384 lds
    s_add_u32 m0, s53, 151104
    s_nop 0
    buffer_load_dwordx4 v243, s[56:59], s52 offen offset:448 lds
    s_add_u32 m0, s53, 155136
    s_nop 0
    buffer_load_dwordx4 v243, s[56:59], s52 offen offset:512 lds
    s_add_u32 m0, s53, 159168
    s_nop 0
    buffer_load_dwordx4 v243, s[56:59], s52 offen offset:576 lds
    s_add_u32 m0, s53, 81280
    s_nop 0
    buffer_load_dwordx4 v243, s[56:59], s52 offen offset:640 lds
    s_add_u32 m0, s53, 85312
    s_nop 0
    buffer_load_dwordx4 v243, s[56:59], s52 offen offset:704 lds
    s_add_u32 m0, s53, 89344
    s_nop 0
    buffer_load_dwordx4 v243, s[56:59], s52 offen offset:768 lds
    s_add_u32 m0, s53, 93376
    s_nop 0
    buffer_load_dwordx4 v243, s[56:59], s52 offen offset:832 lds
    s_add_u32 m0, s53, 97408
    s_nop 0
    buffer_load_dwordx4 v243, s[56:59], s52 offen offset:896 lds
    s_add_u32 m0, s53, 101440
    s_nop 0
    buffer_load_dwordx4 v243, s[56:59], s52 offen offset:960 lds
    s_add_u32 m0, s53, 105472
    s_nop 0
    buffer_load_dwordx4 v243, s[56:59], s52 offen offset:1024 lds
    s_add_u32 m0, s53, 109504
    s_nop 0
    buffer_load_dwordx4 v243, s[56:59], s52 offen offset:1088 lds
    s_add_u32 m0, s53, 113536
    s_nop 0
    buffer_load_dwordx4 v243, s[56:59], s52 offen offset:1152 lds
    s_add_u32 m0, s53, 117568
    s_nop 0
    buffer_load_dwordx4 v243, s[56:59], s52 offen offset:1216 lds
    s_and_b32 s79, s2, 7
    s_lshl_b32 s79, s79, 11
    s_cmp_eq_u32 s49, 7
    s_cselect_b32 s24, 5, 7
    s_and_b32 s25, s2, 7
    s_lshl_b32 s25, s25, 3
    s_add_u32 s25, s25, s49
    s_add_u32 s25, s25, 32
    s_lshl_b32 s25, s25, 10
    v_min_u32 v238, s24, v0
    v_lshl_add_u32 v238, v238, 2, s25
    buffer_load_dword v239, v238, s[20:23], 0 offen sc1
    s_waitcnt vmcnt(0)
    s_branch L_join
L1_w2:
    s_sub_u32 s60, s19, 54
    s_lshl_b32 s54, s60, 2
    s_add_u32 s60, s54, s3
    s_add_u32 s54, s54, 1
    s_add_u32 s77, s60, 168
    s_add_u32 s78, s60, 336
    s_lshl_b32 s76, s3, 8
    s_add_u32 s76, s76, s19
    s_add_u32 s76, s76, 450
    s_lshl_b32 s24, s3, 14
    v_lshrrev_b32 v101, 3, v0
    v_and_b32 v102, 7, v0
    v_mul_u32_u24 v101, 1280, v101
    v_lshl_add_u32 v100, v102, 4, v101
    s_waitcnt lgkmcnt(0)
    s_mov_b32 s56, s4
    s_mov_b32 s57, s5
    s_mov_b32 s58, 0x280000
    s_mov_b32 s59, 0x20000
    s_add_u32 s46, s6, 0x6e4000
    s_addc_u32 s47, s7, 0
    s_load_dword s55, s[46:47], 0
    s_mov_b32 s64, s12
    s_mov_b32 s65, s13
    s_mov_b32 s66, 0x21c000
    s_mov_b32 s67, 0x20000
    s_mul_i32 s68, s60, 6554
    s_lshr_b32 s68, s68, 16
    s_mul_i32 s69, s68, 10
    s_sub_u32 s69, s60, s69
    s_mul_i32 s68, s68, 40960
    s_lshl_b32 s69, s69, 7
    s_add_u32 s68, s68, s69
    s_add_u32 m0, s24, 0
    s_add_u32 s25, s68, 0
    buffer_load_dwordx4 v100, s[64:67], s25 offen nt lds
    s_add_u32 m0, s24, 1024
    s_add_u32 s25, s68, 10240
    buffer_load_dwordx4 v100, s[64:67], s25 offen nt lds
    s_add_u32 m0, s24, 2048
    s_add_u32 s25, s68, 20480
    buffer_load_dwordx4 v100, s[64:67], s25 offen nt lds
    s_add_u32 m0, s24, 3072
    s_add_u32 s25, s68, 30720
    buffer_load_dwordx4 v100, s[64:67], s25 offen nt lds
    s_mul_i32 s68, s77, 6554
    s_lshr_b32 s68, s68, 16
    s_mul_i32 s69, s68, 10
    s_sub_u32 s69, s77, s69
    s_mul_i32 s68, s68, 40960
    s_lshl_b32 s69, s69, 7
    s_add_u32 s68, s68, s69
    s_add_u32 m0, s24, 4096
    s_add_u32 s25, s68, 0
    buffer_load_dwordx4 v100, s[64:67], s25 offen nt lds
    s_add_u32 m0, s24, 5120
    s_add_u32 s25, s68, 10240
    buffer_load_dwordx4 v100, s[64:67], s25 offen nt lds
    s_add_u32 m0, s24, 6144
    s_add_u32 s25, s68, 20480
    buffer_load_dwordx4 v100, s[64:67], s25 offen nt lds
    s_add_u32 m0, s24, 7168
    s_add_u32 s25, s68, 30720
    buffer_load_dwordx4 v100, s[64:67], s25 offen nt lds
    s_mov_b32 s47, s24
    s_and_b32 s44, s2, 7
    s_lshr_b32 s45, s2, 3
    s_lshl_b32 s48, s44, 2
    s_lshr_b32 s24, s45, 3
    s_add_u32 s48, s48, s24
    s_and_b32 s49, s45, 7
    s_lshr_b32 s24, s48, 1
    s_sub_u32 s25, 32, s24
    s_cmp_eq_u32 s48, 1
    s_cselect_b32 s25, 16, s25
    s_and_b32 s48, s48, 1
    s_cselect_b32 s48, s25, s24
    s_sub_u32 s24, 64, s48
    s_cmp_eq_u32 s48, 0
    s_cselect_b32 s24, 32, s24
    s_cmp_lt_u32 s3, 2
    s_cselect_b32 s50, s48, s24
    s_and_b32 s51, s3, 1
    s_lshl_b32 s52, s51, 10
    s_add_u32 s52, s52, s50
    s_mul_i32 s52, s52, 1280
    s_lshl_b32 s53, s3, 10
    v_lshrrev_b32 v241, 2, v0
    v_lshrrev_b32 v242, 3, v0
    v_and_b32 v242, 6, v242
    s_movk_i32 s24, 0x78
    v_lshrrev_b32 v242, v242, s24
    v_xor_b32 v242, v242, v0
    v_and_b32 v242, 3, v242
    v_lshlrev_b32 v242, 4, v242
    s_mov_b32 s24, 81920
    v_mad_u32_u24 v243, v241, s24, v242
    s_mov_b32 s24, s47
    v_lshlrev_b32 v3, 4, v0
    v_lshrrev_b32 v1, 5, v0
    v_and_b32 v2, 31, v0
    v_and_b32 v207, 3, v0
    v_bfe_u32 v193, v0, 2, 1
    v_lshl_add_u32 v207, v193, 4, v207
    v_bfe_u32 v193, v0, 3, 2
    v_lshl_add_u32 v207, v193, 2, v207
    v_mul_u32_u24 v10, 5120, v1
    v_lshl_add_u32 v10, v207, 2, v10
    s_mul_i32 s45, s50, 40960
    s_mul_i32 s44, s51, 640
    s_add_u32 s45, s45, s44
    s_add_u32 s45, s45, 2048
    v_add_u32 v10, s45, v10
    v_add_u32 v11, 10240, v10
    v_add_u32 v12, 20480, v10
    v_add_u32 v13, 30720, v10
    v_cvt_f32_u32 v192, v2
    v_mul_f32 v192, 0x3d000000, v192
    v_cvt_f32_u32 v193, v1
    v_mul_f32 v193, 4.0, v193
    v_add_f32 v194, 0x00000000, v193
    v_mul_f32 v194, v194, v192
    v_add_f32 v195, v194, v192
    v_cos_f32 v196, v194
    v_sin_f32 v197, v194
    v_cos_f32 v198, v195
    v_sin_f32 v199, v195
    v_cvt_pk_f16_f32 v160, v196, v197
    v_cvt_pk_f16_f32 v161, v198, v199
    v_add_f32 v194, 0x40000000, v193
    v_mul_f32 v194, v194, v192
    v_add_f32 v195, v194, v192
    v_cos_f32 v196, v194
    v_sin_f32 v197, v194
    v_cos_f32 v198, v195
    v_sin_f32 v199, v195
    v_cvt_pk_f16_f32 v162, v196, v197
    v_cvt_pk_f16_f32 v163, v198, v199
    v_add_f32 v194, 0x41000000, v193
    v_mul_f32 v194, v194, v192
    v_add_f32 v195, v194, v192
    v_cos_f32 v196, v194
    v_sin_f32 v197, v194
    v_cos_f32 v198, v195
    v_sin_f32 v199, v195
    v_cvt_pk_f16_f32 v164, v196, v197
    v_cvt_pk_f16_f32 v165, v198, v199
    v_add_f32 v194, 0x41200000, v193
    v_mul_f32 v194, v194, v192
    v_add_f32 v195, v194, v192
    v_cos_f32 v196, v194
    v_sin_f32 v197, v194
    v_cos_f32 v198, v195
    v_sin_f32 v199, v195
    v_cvt_pk_f16_f32 v166, v196, v197
    v_cvt_pk_f16_f32 v167, v198, v199
    v_add_f32 v194, 0x41800000, v193
    v_mul_f32 v194, v194, v192
    v_add_f32 v195, v194, v192
    v_cos_f32 v196, v194
    v_sin_f32 v197, v194
    v_cos_f32 v198, v195
    v_sin_f32 v199, v195
    v_cvt_pk_f16_f32 v168, v196, v197
    v_cvt_pk_f16_f32 v169, v198, v199
    v_add_f32 v194, 0x41900000, v193
    v_mul_f32 v194, v194, v192
    v_add_f32 v195, v194, v192
    v_cos_f32 v196, v194
    v_sin_f32 v197, v194
    v_cos_f32 v198, v195
    v_sin_f32 v199, v195
    v_cvt_pk_f16_f32 v170, v196, v197
    v_cvt_pk_f16_f32 v171, v198, v199
    v_add_f32 v194, 0x41c00000, v193
    v_mul_f32 v194, v194, v192
    v_add_f32 v195, v194, v192
    v_cos_f32 v196, v194
    v_sin_f32 v197, v194
    v_cos_f32 v198, v195
    v_sin_f32 v199, v195
    v_cvt_pk_f16_f32 v172, v196, v197
    v_cvt_pk_f16_f32 v173, v198, v199
    v_add_f32 v194, 0x41d00000, v193
    v_mul_f32 v194, v194, v192
    v_add_f32 v195, v194, v192
    v_cos_f32 v196, v194
    v_sin_f32 v197, v194
    v_cos_f32 v198, v195
    v_sin_f32 v199, v195
    v_cvt_pk_f16_f32 v174, v196, v197
    v_cvt_pk_f16_f32 v175, v198, v199
    v_lshlrev_b32 v195, 2, v1
    v_and_b32 v192, 1, v207
    v_lshlrev_b32 v192, 4, v192
    v_mov_b32 v193, 0x3f80
    v_lshlrev_b32 v192, v192, v193
    v_lshrrev_b32 v193, 1, v207
    v_sub_u32 v193, v193, v195
    v_cmp_eq_u32 s[46:47], 0, v193
    v_cmp_eq_u32 vcc, 1, v193
    s_nop 0
    v_cndmask_b32 v176, 0, v192, s[46:47]
    v_cndmask_b32 v177, 0, v192, vcc
    v_cmp_eq_u32 s[46:47], 2, v193
    v_cmp_eq_u32 vcc, 3, v193
    s_nop 0
    v_cndmask_b32 v178, 0, v192, s[46:47]
    v_cndmask_b32 v179, 0, v192, vcc
    v_cmp_eq_u32 s[46:47], 8, v193
    v_cmp_eq_u32 vcc, 9, v193
    s_nop 0
    v_cndmask_b32 v180, 0, v192, s[46:47]
    v_cndmask_b32 v181, 0, v192, vcc
    v_cmp_eq_u32 s[46:47], 10, v193
    v_cmp_eq_u32 vcc, 11, v193
    s_nop 0
    v_cndmask_b32 v182, 0, v192, s[46:47]
    v_cndmask_b32 v183, 0, v192, vcc
    v_sub_u32 v196, 32, v207
    v_and_b32 v192, 1, v196
    v_lshlrev_b32 v192, 4, v192
    v_mov_b32 v193, 0x3f80
    v_lshlrev_b32 v192, v192, v193
    v_lshrrev_b32 v193, 1, v196
    v_sub_u32 v193, v193, v195
    v_cmp_eq_u32 s[46:47], 0, v193
    v_cmp_eq_u32 vcc, 1, v193
    s_nop 0
    v_cndmask_b32 v184, 0, v192, s[46:47]
    v_cndmask_b32 v185, 0, v192, vcc
    v_cmp_eq_u32 s[46:47], 2, v193
    v_cmp_eq_u32 vcc, 3, v193
    s_nop 0
    v_cndmask_b32 v186, 0, v192, s[46:47]
    v_cndmask_b32 v187, 0, v192, vcc
    v_cmp_eq_u32 s[46:47], 8, v193
    v_cmp_eq_u32 vcc, 9, v193
    s_nop 0
    v_cndmask_b32 v188, 0, v192, s[46:47]
    v_cndmask_b32 v189, 0, v192, vcc
    v_cmp_eq_u32 s[46:47], 10, v193
    v_cmp_eq_u32 vcc, 11, v193
    s_nop 0
    v_cndmask_b32 v190, 0, v192, s[46:47]
    v_cndmask_b32 v191, 0, v192, vcc
    v_add_u32 v4, 4096, v3
    s_lshr_b32 s45, s3, 1
    s_lshl_b32 s45, s45, 5
    v_add_u32 v192, s45, v2
    v_lshlrev_b32 v193, 6, v2
    v_add_u32 v193, s50, v193
    v_sub_u32 v193, 2048, v193
    v_and_b32 v194, 63, v193
    v_bfe_u32 v193, v193, 6, 5
    v_cmp_ne_u32 s[46:47], s48, v194
    s_nop 1
    v_cndmask_b32 v194, 0, 32, s[46:47]
    v_add_u32 v193, v193, v194
    v_lshrrev_b32 v194, 1, v192
    v_and_b32 v194, 6, v194
    s_movk_i32 s44, 0x78
    v_bfe_u32 v194, s44, v194, 2
    v_lshlrev_b32 v194, 4, v194
    v_lshl_add_u32 v194, v192, 6, v194
    s_mul_i32 s44, s51, 20480
    s_add_u32 s45, s44, 122880
    v_add_u32 v194, s45, v194
    v_lshrrev_b32 v196, 1, v193
    v_and_b32 v196, 6, v196
    s_movk_i32 s44, 0x78
    v_bfe_u32 v196, s44, v196, 2
    v_lshlrev_b32 v196, 4, v196
    v_lshl_add_u32 v196, v193, 6, v196
    s_mul_i32 s44, s51, 20480
    s_sub_u32 s44, 61440, s44
    v_add_u32 v196, s44, v196
    v_lshlrev_b32 v197, 4, v1
    v_lshlrev_b32 v198, 5, v1
    v_xor_b32 v14, v194, v198
    v_xor_b32 v15, 16, v14
    v_xor_b32 v16, v196, v198
    v_xor_b32 v16, 32, v16
    v_xor_b32 v17, 16, v16
    v_xor_b32 v18, v194, v197
    v_xor_b32 v19, 32, v18
    v_xor_b32 v20, v196, v197
    v_xor_b32 v21, 32, v20
    v_add_u32 v22, 4096, v196
    s_cmp_eq_u32 s51, 0
    s_cselect_b32 s44, 40960, 0
    v_subrev_u32 v23, s44, v22
    v_or_b32 v197, s51, v1
    v_cmp_eq_u32 s[46:47], 0, v197
    s_nop 1
    v_cndmask_b32 v24, 0, -1.0, s[46:47]
    v_cvt_f32_u32 v25, v1
    v_sub_f32 v25, 1.0, v25
    v_lshrrev_b32 v194, 1, v0
    v_and_b32 v194, 6, v194
    s_movk_i32 s44, 0x78
    v_bfe_u32 v194, s44, v194, 2
    v_lshrrev_b32 v195, 4, v0
    v_xor_b32 v194, v194, v195
    v_lshlrev_b32 v194, 4, v194
    v_and_b32 v195, 15, v0
    v_lshl_add_u32 v194, v195, 6, v194
    s_mul_i32 s44, s51, -80896
    s_add_u32 s44, s44, 122880
    v_add_u32 v5, s44, v194
    v_xor_b32 v6, 1024, v5
    s_mul_i32 s44, s51, 82944
    s_add_u32 s44, s44, 40960
    v_add_u32 v7, s44, v194
    v_xor_b32 v8, 1024, v7
    v_mov_b32 v128, 0
    v_mov_b32 v148, 0
    v_mov_b32 v26, 0
    v_mov_b32 v27, 0
    v_mov_b32 v28, 0
    v_mov_b32 v29, 0
    v_mov_b32 v152, 0x3f803f80
    s_lshl_b32 s44, s51, 4
    s_add_u32 s44, s44, 22016
    v_lshl_add_u32 v197, v1, 3, s44
    v_lshl_add_u32 v30, v192, 6, v197
    v_lshl_add_u32 v31, v193, 6, v197
    s_waitcnt lgkmcnt(0)
    s_mul_i32 s55, s55, 0x9e3779b1
    s_add_u32 s55, s55, 0x7f4a7c15
    s_add_u32 s20, s6, 0x6e0000
    s_addc_u32 s21, s7, 0
    s_mov_b32 s22, 0x18000
    s_mov_b32 s23, 0x20000
    v_and_b32 v193, 15, v207
    v_lshlrev_b32 v193, 1, v193
    v_lshrrev_b32 v193, v193, s55
    v_and_b32 v9, 1, v193
    v_bfe_u32 v193, v193, 1, 1
    v_lshl_or_b32 v9, v193, 16, v9
    s_mul_i32 s68, s78, 6554
    s_lshr_b32 s68, s68, 16
    s_mul_i32 s69, s68, 10
    s_sub_u32 s69, s78, s69
    s_mul_i32 s68, s68, 40960
    s_lshl_b32 s69, s69, 7
    s_add_u32 s68, s68, s69
    s_add_u32 m0, s24, 8192
    s_add_u32 s25, s68, 0
    buffer_load_dwordx4 v100, s[64:67], s25 offen nt lds
    s_add_u32 m0, s24, 9216
    s_add_u32 s25, s68, 10240
    buffer_load_dwordx4 v100, s[64:67], s25 offen nt lds
    s_add_u32 m0, s24, 10240
    s_add_u32 s25, s68, 20480
    buffer_load_dwordx4 v100, s[64:67], s25 offen nt lds
    s_add_u32 m0, s24, 11264
    s_add_u32 s25, s68, 30720
    buffer_load_dwordx4 v100, s[64:67], s25 offen nt lds
    s_cmp_ge_u32 s76, 540
    s_cbranch_scc1 L1_q3a
    s_mul_i32 s68, s76, 6554
    s_lshr_b32 s68, s68, 16
    s_mul_i32 s69, s68, 10
    s_sub_u32 s69, s76, s69
    s_mul_i32 s68, s68, 40960
    s_lshl_b32 s69, s69, 7
    s_add_u32 s68, s68, s69
    s_add_u32 m0, s24, 12288
    s_add_u32 s25, s68, 0
    buffer_load_dwordx4 v100, s[64:67], s25 offen nt lds
    s_add_u32 m0, s24, 13312
    s_add_u32 s25, s68, 10240
    buffer_load_dwordx4 v100, s[64:67], s25 offen nt lds
    s_add_u32 m0, s24, 14336
    s_add_u32 s25, s68, 20480
    buffer_load_dwordx4 v100, s[64:67], s25 offen nt lds
    s_add_u32 m0, s24, 15360
    s_add_u32 s25, s68, 30720
    buffer_load_dwordx4 v100, s[64:67], s25 offen nt lds
L1_q3a:
    s_add_u32 s72, s6, 0x4c0000
    s_addc_u32 s73, s7, 0
    s_mov_b32 s74, 0x21c000
    s_mov_b32 s75, 0x20000
    v_bfe_u32 v101, v0, 2, 2
    v_lshrrev_b32 v102, 4, v0
    v_lshl_add_u32 v101, v102, 3, v101
    v_lshlrev_b32 v101, 7, v101
    v_and_b32 v102, 3, v0
    v_lshl_add_u32 v101, v102, 3, v101
    v_add_u32 v101, s24, v101
    v_lshlrev_b32 v102, 4, v0
    s_mul_i32 s68, s60, 6554
    s_lshr_b32 s68, s68, 16
    s_mul_i32 s69, s68, 10
    s_sub_u32 s69, s60, s69
    s_lshl_b32 s69, s69, 2
    s_mul_i32 s68, s68, 5120
    s_cmp_ge_u32 s60, 540
    s_cselect_b32 s68, 0x40000000, s68
    s_waitcnt vmcnt(8)
    ds_read_b64_tr_b16 v[32:33], v101 offset:0
    ds_read_b64_tr_b16 v[34:35], v101 offset:512
    ds_read_b64_tr_b16 v[36:37], v101 offset:32
    ds_read_b64_tr_b16 v[38:39], v101 offset:544
    ds_read_b64_tr_b16 v[40:41], v101 offset:64
    ds_read_b64_tr_b16 v[42:43], v101 offset:576
    ds_read_b64_tr_b16 v[44:45], v101 offset:96
    ds_read_b64_tr_b16 v[46:47], v101 offset:608
    s_add_u32 s70, s69, 0
    s_mul_i32 s71, s70, 13108
    s_lshr_b32 s71, s71, 16
    s_lshl_b32 s70, s70, 10
    s_mul_i32 s71, s71, 271360
    s_add_u32 s70, s70, s71
    s_add_u32 s70, s70, s68
    s_waitcnt lgkmcnt(6)
    buffer_store_dwordx4 v[32:35], v102, s[72:75], s70 offen sc1
    s_add_u32 s70, s69, 1
    s_mul_i32 s71, s70, 13108
    s_lshr_b32 s71, s71, 16
    s_lshl_b32 s70, s70, 10
    s_mul_i32 s71, s71, 271360
    s_add_u32 s70, s70, s71
    s_add_u32 s70, s70, s68
    s_waitcnt lgkmcnt(4)
    buffer_store_dwordx4 v[36:39], v102, s[72:75], s70 offen sc1
    s_add_u32 s70, s69, 2
    s_mul_i32 s71, s70, 13108
    s_lshr_b32 s71, s71, 16
    s_lshl_b32 s70, s70, 10
    s_mul_i32 s71, s71, 271360
    s_add_u32 s70, s70, s71
    s_add_u32 s70, s70, s68
    s_waitcnt lgkmcnt(2)
    buffer_store_dwordx4 v[40:43], v102, s[72:75], s70 offen sc1
    s_add_u32 s70, s69, 3
    s_mul_i32 s71, s70, 13108
    s_lshr_b32 s71, s71, 16
    s_lshl_b32 s70, s70, 10
    s_mul_i32 s71, s71, 271360
    s_add_u32 s70, s70, s71
    s_add_u32 s70, s70, s68
    s_waitcnt lgkmcnt(0)
    buffer_store_dwordx4 v[44:47], v102, s[72:75], s70 offen sc1
    s_mul_i32 s68, s77, 6554
    s_lshr_b32 s68, s68, 16
    s_mul_i32 s69, s68, 10
    s_sub_u32 s69, s77, s69
    s_lshl_b32 s69, s69, 2
    s_mul_i32 s68, s68, 5120
    s_cmp_ge_u32 s77, 540
    s_cselect_b32 s68, 0x40000000, s68
    s_waitcnt vmcnt(8)
    ds_read_b64_tr_b16 v[48:49], v101 offset:4096
    ds_read_b64_tr_b16 v[50:51], v101 offset:4608
    ds_read_b64_tr_b16 v[52:53], v101 offset:4128
    ds_read_b64_tr_b16 v[54:55], v101 offset:4640
    ds_read_b64_tr_b16 v[56:57], v101 offset:4160
    ds_read_b64_tr_b16 v[58:59], v101 offset:4672
    ds_read_b64_tr_b16 v[60:61], v101 offset:4192
    ds_read_b64_tr_b16 v[62:63], v101 offset:4704
    s_add_u32 s70, s69, 0
    s_mul_i32 s71, s70, 13108
    s_lshr_b32 s71, s71, 16
    s_lshl_b32 s70, s70, 10
    s_mul_i32 s71, s71, 271360
    s_add_u32 s70, s70, s71
    s_add_u32 s70, s70, s68
    s_waitcnt lgkmcnt(6)
    buffer_store_dwordx4 v[48:51], v102, s[72:75], s70 offen sc1
    s_add_u32 s70, s69, 1
    s_mul_i32 s71, s70, 13108
    s_lshr_b32 s71, s71, 16
    s_lshl_b32 s70, s70, 10
    s_mul_i32 s71, s71, 271360
    s_add_u32 s70, s70, s71
    s_add_u32 s70, s70, s68
    s_waitcnt lgkmcnt(4)
    buffer_store_dwordx4 v[52:55], v102, s[72:75], s70 offen sc1
    s_add_u32 s70, s69, 2
    s_mul_i32 s71, s70, 13108
    s_lshr_b32 s71, s71, 16
    s_lshl_b32 s70, s70, 10
    s_mul_i32 s71, s71, 271360
    s_add_u32 s70, s70, s71
    s_add_u32 s70, s70, s68
    s_waitcnt lgkmcnt(2)
    buffer_store_dwordx4 v[56:59], v102, s[72:75], s70 offen sc1
    s_add_u32 s70, s69, 3
    s_mul_i32 s71, s70, 13108
    s_lshr_b32 s71, s71, 16
    s_lshl_b32 s70, s70, 10
    s_mul_i32 s71, s71, 271360
    s_add_u32 s70, s70, s71
    s_add_u32 s70, s70, s68
    s_waitcnt lgkmcnt(0)
    buffer_store_dwordx4 v[60:63], v102, s[72:75], s70 offen sc1
    s_mul_i32 s68, s78, 6554
    s_lshr_b32 s68, s68, 16
    s_mul_i32 s69, s68, 10
    s_sub_u32 s69, s78, s69
    s_lshl_b32 s69, s69, 2
    s_mul_i32 s68, s68, 5120
    s_cmp_ge_u32 s78, 540
    s_cselect_b32 s68, 0x40000000, s68
    s_waitcnt vmcnt(8)
    ds_read_b64_tr_b16 v[64:65], v101 offset:8192
    ds_read_b64_tr_b16 v[66:67], v101 offset:8704
    ds_read_b64_tr_b16 v[68:69], v101 offset:8224
    ds_read_b64_tr_b16 v[70:71], v101 offset:8736
    ds_read_b64_tr_b16 v[72:73], v101 offset:8256
    ds_read_b64_tr_b16 v[74:75], v101 offset:8768
    ds_read_b64_tr_b16 v[76:77], v101 offset:8288
    ds_read_b64_tr_b16 v[78:79], v101 offset:8800
    s_add_u32 s70, s69, 0
    s_mul_i32 s71, s70, 13108
    s_lshr_b32 s71, s71, 16
    s_lshl_b32 s70, s70, 10
    s_mul_i32 s71, s71, 271360
    s_add_u32 s70, s70, s71
    s_add_u32 s70, s70, s68
    s_waitcnt lgkmcnt(6)
    buffer_store_dwordx4 v[64:67], v102, s[72:75], s70 offen sc1
    s_add_u32 s70, s69, 1
    s_mul_i32 s71, s70, 13108
    s_lshr_b32 s71, s71, 16
    s_lshl_b32 s70, s70, 10
    s_mul_i32 s71, s71, 271360
    s_add_u32 s70, s70, s71
    s_add_u32 s70, s70, s68
    s_waitcnt lgkmcnt(4)
    buffer_store_dwordx4 v[68:71], v102, s[72:75], s70 offen sc1
    s_add_u32 s70, s69, 2
    s_mul_i32 s71, s70, 13108
    s_lshr_b32 s71, s71, 16
    s_lshl_b32 s70, s70, 10
    s_mul_i32 s71, s71, 271360
    s_add_u32 s70, s70, s71
    s_add_u32 s70, s70, s68
    s_waitcnt lgkmcnt(2)
    buffer_store_dwordx4 v[72:75], v102, s[72:75], s70 offen sc1
    s_add_u32 s70, s69, 3
    s_mul_i32 s71, s70, 13108
    s_lshr_b32 s71, s71, 16
    s_lshl_b32 s70, s70, 10
    s_mul_i32 s71, s71, 271360
    s_add_u32 s70, s70, s71
    s_add_u32 s70, s70, s68
    s_waitcnt lgkmcnt(0)
    buffer_store_dwordx4 v[76:79], v102, s[72:75], s70 offen sc1
    s_add_u32 m0, s53, 122880
    s_nop 0
    buffer_load_dwordx4 v243, s[56:59], s52 offen offset:0 lds
    s_add_u32 m0, s53, 126912
    s_nop 0
    buffer_load_dwordx4 v243, s[56:59], s52 offen offset:64 lds
    s_add_u32 m0, s53, 130944
    s_nop 0
    buffer_load_dwordx4 v243, s[56:59], s52 offen offset:128 lds
    s_add_u32 m0, s53, 134976
    s_nop 0
    buffer_load_dwordx4 v243, s[56:59], s52 offen offset:192 lds
    s_add_u32 m0, s53, 139008
    s_nop 0
    buffer_load_dwordx4 v243, s[56:59], s52 offen offset:256 lds
    s_add_u32 m0, s53, 143040
    s_nop 0
    buffer_load_dwordx4 v243, s[56:59], s52 offen offset:320 lds
    s_add_u32 m0, s53, 147072
    s_nop 0
    buffer_load_dwordx4 v243, s[56:59], s52 offen offset:384 lds
    s_add_u32 m0, s53, 151104
    s_nop 0
    buffer_load_dwordx4 v243, s[56:59], s52 offen offset:448 lds
    s_add_u32 m0, s53, 155136
    s_nop 0
    buffer_load_dwordx4 v243, s[56:59], s52 offen offset:512 lds
    s_add_u32 m0, s53, 159168
    s_nop 0
    buffer_load_dwordx4 v243, s[56:59], s52 offen offset:576 lds
    s_add_u32 m0, s53, 81280
    s_nop 0
    buffer_load_dwordx4 v243, s[56:59], s52 offen offset:640 lds
    s_add_u32 m0, s53, 85312
    s_nop 0
    buffer_load_dwordx4 v243, s[56:59], s52 offen offset:704 lds
    s_add_u32 m0, s53, 89344
    s_nop 0
    buffer_load_dwordx4 v243, s[56:59], s52 offen offset:768 lds
    s_add_u32 m0, s53, 93376
    s_nop 0
    buffer_load_dwordx4 v243, s[56:59], s52 offen offset:832 lds
    s_add_u32 m0, s53, 97408
    s_nop 0
    buffer_load_dwordx4 v243, s[56:59], s52 offen offset:896 lds
    s_add_u32 m0, s53, 101440
    s_nop 0
    buffer_load_dwordx4 v243, s[56:59], s52 offen offset:960 lds
    s_add_u32 m0, s53, 105472
    s_nop 0
    buffer_load_dwordx4 v243, s[56:59], s52 offen offset:1024 lds
    s_add_u32 m0, s53, 109504
    s_nop 0
    buffer_load_dwordx4 v243, s[56:59], s52 offen offset:1088 lds
    s_add_u32 m0, s53, 113536
    s_nop 0
    buffer_load_dwordx4 v243, s[56:59], s52 offen offset:1152 lds
    s_add_u32 m0, s53, 117568
    s_nop 0
    buffer_load_dwordx4 v243, s[56:59], s52 offen offset:1216 lds
    s_and_b32 s79, s2, 7
    s_lshl_b32 s79, s79, 11
    s_cmp_eq_u32 s49, 7
    s_cselect_b32 s24, 5, 7
    s_and_b32 s25, s2, 7
    s_lshl_b32 s25, s25, 3
    s_add_u32 s25, s25, s49
    s_add_u32 s25, s25, 32
    s_lshl_b32 s25, s25, 10
    v_min_u32 v238, s24, v0
    v_lshl_add_u32 v238, v238, 2, s25
    buffer_load_dword v239, v238, s[20:23], 0 offen sc1
    s_waitcnt vmcnt(0)
    s_cmp_ge_u32 s76, 540
    s_cbranch_scc1 L1_q3b
    s_mul_i32 s68, s76, 6554
    s_lshr_b32 s68, s68, 16
    s_mul_i32 s69, s68, 10
    s_sub_u32 s69, s76, s69
    s_lshl_b32 s69, s69, 2
    s_mul_i32 s68, s68, 5120
    s_cmp_ge_u32 s76, 540
    s_cselect_b32 s68, 0x40000000, s68
    ds_read_b64_tr_b16 v[80:81], v101 offset:12288
    ds_read_b64_tr_b16 v[82:83], v101 offset:12800
    ds_read_b64_tr_b16 v[84:85], v101 offset:12320
    ds_read_b64_tr_b16 v[86:87], v101 offset:12832
    ds_read_b64_tr_b16 v[88:89], v101 offset:12352
    ds_read_b64_tr_b16 v[90:91], v101 offset:12864
    ds_read_b64_tr_b16 v[92:93], v101 offset:12384
    ds_read_b64_tr_b16 v[94:95], v101 offset:12896
    s_add_u32 s70, s69, 0
    s_mul_i32 s71, s70, 13108
    s_lshr_b32 s71, s71, 16
    s_lshl_b32 s70, s70, 10
    s_mul_i32 s71, s71, 271360
    s_add_u32 s70, s70, s71
    s_add_u32 s70, s70, s68
    s_waitcnt lgkmcnt(6)
    buffer_store_dwordx4 v[80:83], v102, s[72:75], s70 offen sc1
    s_add_u32 s70, s69, 1
    s_mul_i32 s71, s70, 13108
    s_lshr_b32 s71, s71, 16
    s_lshl_b32 s70, s70, 10
    s_mul_i32 s71, s71, 271360
    s_add_u32 s70, s70, s71
    s_add_u32 s70, s70, s68
    s_waitcnt lgkmcnt(4)
    buffer_store_dwordx4 v[84:87], v102, s[72:75], s70 offen sc1
    s_add_u32 s70, s69, 2
    s_mul_i32 s71, s70, 13108
    s_lshr_b32 s71, s71, 16
    s_lshl_b32 s70, s70, 10
    s_mul_i32 s71, s71, 271360
    s_add_u32 s70, s70, s71
    s_add_u32 s70, s70, s68
    s_waitcnt lgkmcnt(2)
    buffer_store_dwordx4 v[88:91], v102, s[72:75], s70 offen sc1
    s_add_u32 s70, s69, 3
    s_mul_i32 s71, s70, 13108
    s_lshr_b32 s71, s71, 16
    s_lshl_b32 s70, s70, 10
    s_mul_i32 s71, s71, 271360
    s_add_u32 s70, s70, s71
    s_add_u32 s70, s70, s68
    s_waitcnt lgkmcnt(0)
    buffer_store_dwordx4 v[92:95], v102, s[72:75], s70 offen sc1
L1_q3b:
    s_branch L_join
L_code_end:
L_vsz0:
    s_add_u32 s46, s46, 1
    s_cmp_ge_u32 s46, 0x40000
    s_cbranch_scc1 L_vgz0
    s_sleep 4
    global_load_dword v32, v10, s[6:7] offset:-2048 sc1
    global_load_dword v33, v10, s[6:7] offset:-768 sc1
    global_load_dword v34, v10, s[6:7] offset:512 sc1
    global_load_dword v35, v10, s[6:7] offset:1792 sc1
    global_load_dword v36, v11, s[6:7] offset:-2048 sc1
    global_load_dword v37, v11, s[6:7] offset:-768 sc1
    global_load_dword v38, v11, s[6:7] offset:512 sc1
    global_load_dword v39, v11, s[6:7] offset:1792 sc1
    global_load_dword v40, v12, s[6:7] offset:-2048 sc1
    global_load_dword v41, v12, s[6:7] offset:-768 sc1
    global_load_dword v42, v12, s[6:7] offset:512 sc1
    global_load_dword v43, v12, s[6:7] offset:1792 sc1
    global_load_dword v44, v13, s[6:7] offset:-2048 sc1
    global_load_dword v45, v13, s[6:7] offset:-768 sc1
    global_load_dword v46, v13, s[6:7] offset:512 sc1
    global_load_dword v47, v13, s[6:7] offset:1792 sc1
    global_load_dword v48, v10, s[6:7] offset:-1920 sc1
    global_load_dword v49, v10, s[6:7] offset:-640 sc1
    global_load_dword v50, v10, s[6:7] offset:640 sc1
    global_load_dword v51, v10, s[6:7] offset:1920 sc1
    global_load_dword v52, v11, s[6:7] offset:-1920 sc1
    global_load_dword v53, v11, s[6:7] offset:-640 sc1
    global_load_dword v54, v11, s[6:7] offset:640 sc1
    global_load_dword v55, v11, s[6:7] offset:1920 sc1
    global_load_dword v56, v12, s[6:7] offset:-1920 sc1
    global_load_dword v57, v12, s[6:7] offset:-640 sc1
    global_load_dword v58, v12, s[6:7] offset:640 sc1
    global_load_dword v59, v12, s[6:7] offset:1920 sc1
    global_load_dword v60, v13, s[6:7] offset:-1920 sc1
    global_load_dword v61, v13, s[6:7] offset:-640 sc1
    global_load_dword v62, v13, s[6:7] offset:640 sc1
    global_load_dword v63, v13, s[6:7] offset:1920 sc1
    global_load_dword v64, v10, s[6:7] offset:-1792 sc1
    global_load_dword v65, v10, s[6:7] offset:-512 sc1
    global_load_dword v66, v10, s[6:7] offset:768 sc1
    global_load_dword v67, v10, s[6:7] offset:2048 sc1
    global_load_dword v68, v11, s[6:7] offset:-1792 sc1
    global_load_dword v69, v11, s[6:7] offset:-512 sc1
    global_load_dword v70, v11, s[6:7] offset:768 sc1
    global_load_dword v71, v11, s[6:7] offset:2048 sc1
    global_load_dword v72, v12, s[6:7] offset:-1792 sc1
    global_load_dword v73, v12, s[6:7] offset:-512 sc1
    global_load_dword v74, v12, s[6:7] offset:768 sc1
    global_load_dword v75, v12, s[6:7] offset:2048 sc1
    global_load_dword v76, v13, s[6:7] offset:-1792 sc1
    global_load_dword v77, v13, s[6:7] offset:-512 sc1
    global_load_dword v78, v13, s[6:7] offset:768 sc1
    global_load_dword v79, v13, s[6:7] offset:2048 sc1
    global_load_dword v80, v10, s[6:7] offset:-1664 sc1
    global_load_dword v81, v10, s[6:7] offset:-384 sc1
    global_load_dword v82, v10, s[6:7] offset:896 sc1
    global_load_dword v83, v10, s[6:7] offset:2176 sc1
    global_load_dword v84, v11, s[6:7] offset:-1664 sc1
    global_load_dword v85, v11, s[6:7] offset:-384 sc1
    global_load_dword v86, v11, s[6:7] offset:896 sc1
    global_load_dword v87, v11, s[6:7] offset:2176 sc1
    global_load_dword v88, v12, s[6:7] offset:-1664 sc1
    global_load_dword v89, v12, s[6:7] offset:-384 sc1
    global_load_dword v90, v12, s[6:7] offset:896 sc1
    global_load_dword v91, v12, s[6:7] offset:2176 sc1
    global_load_dword v92, v13, s[6:7] offset:-1664 sc1
    global_load_dword v93, v13, s[6:7] offset:-384 sc1
    global_load_dword v94, v13, s[6:7] offset:896 sc1
    global_load_dword v95, v13, s[6:7] offset:2176 sc1
    s_waitcnt vmcnt(0)
    v_xor_b32 v32, v9, v32
    v_xor_b32 v33, v9, v33
    v_xor_b32 v34, v9, v34
    v_xor_b32 v35, v9, v35
    v_or3_b32 v153, v32, v33, v34
    v_xor_b32 v36, v9, v36
    v_xor_b32 v37, v9, v37
    v_or3_b32 v153, v153, v35, v36
    v_xor_b32 v38, v9, v38
    v_xor_b32 v39, v9, v39
    v_or3_b32 v153, v153, v37, v38
    v_xor_b32 v40, v9, v40
    v_xor_b32 v41, v9, v41
    v_or3_b32 v153, v153, v39, v40
    v_xor_b32 v42, v9, v42
    v_xor_b32 v43, v9, v43
    v_or3_b32 v153, v153, v41, v42
    v_xor_b32 v44, v9, v44
    v_xor_b32 v45, v9, v45
    v_or3_b32 v153, v153, v43, v44
    v_xor_b32 v46, v9, v46
    v_xor_b32 v47, v9, v47
    v_or3_b32 v153, v153, v45, v46
    v_or_b32 v153, v153, v47
    v_and_b32 v153, 0x10001, v153
    v_cmp_ne_u32 vcc, 0, v153
    s_cbranch_vccnz L_vsz0
    s_nop 1
    s_branch L_vgz0
L_vsz1:
    s_add_u32 s46, s46, 1
    s_cmp_ge_u32 s46, 0x40000
    s_cbranch_scc1 L_vgz1
    s_sleep 4
    global_load_dword v48, v10, s[6:7] offset:-1920 sc1
    global_load_dword v49, v10, s[6:7] offset:-640 sc1
    global_load_dword v50, v10, s[6:7] offset:640 sc1
    global_load_dword v51, v10, s[6:7] offset:1920 sc1
    global_load_dword v52, v11, s[6:7] offset:-1920 sc1
    global_load_dword v53, v11, s[6:7] offset:-640 sc1
    global_load_dword v54, v11, s[6:7] offset:640 sc1
    global_load_dword v55, v11, s[6:7] offset:1920 sc1
    global_load_dword v56, v12, s[6:7] offset:-1920 sc1
    global_load_dword v57, v12, s[6:7] offset:-640 sc1
    global_load_dword v58, v12, s[6:7] offset:640 sc1
    global_load_dword v59, v12, s[6:7] offset:1920 sc1
    global_load_dword v60, v13, s[6:7] offset:-1920 sc1
    global_load_dword v61, v13, s[6:7] offset:-640 sc1
    global_load_dword v62, v13, s[6:7] offset:640 sc1
    global_load_dword v63, v13, s[6:7] offset:1920 sc1
    global_load_dword v64, v10, s[6:7] offset:-1792 sc1
    global_load_dword v65, v10, s[6:7] offset:-512 sc1
    global_load_dword v66, v10, s[6:7] offset:768 sc1
    global_load_dword v67, v10, s[6:7] offset:2048 sc1
    global_load_dword v68, v11, s[6:7] offset:-1792 sc1
    global_load_dword v69, v11, s[6:7] offset:-512 sc1
    global_load_dword v70, v11, s[6:7] offset:768 sc1
    global_load_dword v71, v11, s[6:7] offset:2048 sc1
    global_load_dword v72, v12, s[6:7] offset:-1792 sc1
    global_load_dword v73, v12, s[6:7] offset:-512 sc1
    global_load_dword v74, v12, s[6:7] offset:768 sc1
    global_load_dword v75, v12, s[6:7] offset:2048 sc1
    global_load_dword v76, v13, s[6:7] offset:-1792 sc1
    global_load_dword v77, v13, s[6:7] offset:-512 sc1
    global_load_dword v78, v13, s[6:7] offset:768 sc1
    global_load_dword v79, v13, s[6:7] offset:2048 sc1
    global_load_dword v80, v10, s[6:7] offset:-1664 sc1
    global_load_dword v81, v10, s[6:7] offset:-384 sc1
    global_load_dword v82, v10, s[6:7] offset:896 sc1
    global_load_dword v83, v10, s[6:7] offset:2176 sc1
    global_load_dword v84, v11, s[6:7] offset:-1664 sc1
    global_load_dword v85, v11, s[6:7] offset:-384 sc1
    global_load_dword v86, v11, s[6:7] offset:896 sc1
    global_load_dword v87, v11, s[6:7] offset:2176 sc1
    global_load_dword v88, v12, s[6:7] offset:-1664 sc1
    global_load_dword v89, v12, s[6:7] offset:-384 sc1
    global_load_dword v90, v12, s[6:7] offset:896 sc1
    global_load_dword v91, v12, s[6:7] offset:2176 sc1
    global_load_dword v92, v13, s[6:7] offset:-1664 sc1
    global_load_dword v93, v13, s[6:7] offset:-384 sc1
    global_load_dword v94, v13, s[6:7] offset:896 sc1
    global_load_dword v95, v13, s[6:7] offset:2176 sc1
    global_load_dword v96, v10, s[6:7] offset:-1536 sc1
    global_load_dword v97, v10, s[6:7] offset:-256 sc1
    global_load_dword v98, v10, s[6:7] offset:1024 sc1
    global_load_dword v99, v10, s[6:7] offset:2304 sc1
    global_load_dword v100, v11, s[6:7] offset:-1536 sc1
    global_load_dword v101, v11, s[6:7] offset:-256 sc1
    global_load_dword v102, v11, s[6:7] offset:1024 sc1
    global_load_dword v103, v11, s[6:7] offset:2304 sc1
    global_load_dword v104, v12, s[6:7] offset:-1536 sc1
    global_load_dword v105, v12, s[6:7] offset:-256 sc1
    global_load_dword v106, v12, s[6:7] offset:1024 sc1
    global_load_dword v107, v12, s[6:7] offset:2304 sc1
    global_load_dword v108, v13, s[6:7] offset:-1536 sc1
    global_load_dword v109, v13, s[6:7] offset:-256 sc1
    global_load_dword v110, v13, s[6:7] offset:1024 sc1
    global_load_dword v111, v13, s[6:7] offset:2304 sc1
    s_waitcnt vmcnt(0)
    v_xor_b32 v48, v9, v48
    v_xor_b32 v49, v9, v49
    v_xor_b32 v50, v9, v50
    v_xor_b32 v51, v9, v51
    v_or3_b32 v153, v48, v49, v50
    v_xor_b32 v52, v9, v52
    v_xor_b32 v53, v9, v53
    v_or3_b32 v153, v153, v51, v52
    v_xor_b32 v54, v9, v54
    v_xor_b32 v55, v9, v55
    v_or3_b32 v153, v153, v53, v54
    v_xor_b32 v56, v9, v56
    v_xor_b32 v57, v9, v57
    v_or3_b32 v153, v153, v55, v56
    v_xor_b32 v58, v9, v58
    v_xor_b32 v59, v9, v59
    v_or3_b32 v153, v153, v57, v58
    v_xor_b32 v60, v9, v60
    v_xor_b32 v61, v9, v61
    v_or3_b32 v153, v153, v59, v60
    v_xor_b32 v62, v9, v62
    v_xor_b32 v63, v9, v63
    v_or3_b32 v153, v153, v61, v62
    v_or_b32 v153, v153, v63
    v_and_b32 v153, 0x10001, v153
    v_cmp_ne_u32 vcc, 0, v153
    s_cbranch_vccnz L_vsz1
    s_nop 1
    s_branch L_vgz1
L_vsz2:
    s_add_u32 s46, s46, 1
    s_cmp_ge_u32 s46, 0x40000
    s_cbranch_scc1 L_vgz2
    s_sleep 4
    global_load_dword v64, v10, s[6:7] offset:-1792 sc1
    global_load_dword v65, v10, s[6:7] offset:-512 sc1
    global_load_dword v66, v10, s[6:7] offset:768 sc1
    global_load_dword v67, v10, s[6:7] offset:2048 sc1
    global_load_dword v68, v11, s[6:7] offset:-1792 sc1
    global_load_dword v69, v11, s[6:7] offset:-512 sc1
    global_load_dword v70, v11, s[6:7] offset:768 sc1
    global_load_dword v71, v11, s[6:7] offset:2048 sc1
    global_load_dword v72, v12, s[6:7] offset:-1792 sc1
    global_load_dword v73, v12, s[6:7] offset:-512 sc1
    global_load_dword v74, v12, s[6:7] offset:768 sc1
    global_load_dword v75, v12, s[6:7] offset:2048 sc1
    global_load_dword v76, v13, s[6:7] offset:-1792 sc1
    global_load_dword v77, v13, s[6:7] offset:-512 sc1
    global_load_dword v78, v13, s[6:7] offset:768 sc1
    global_load_dword v79, v13, s[6:7] offset:2048 sc1
    global_load_dword v80, v10, s[6:7] offset:-1664 sc1
    global_load_dword v81, v10, s[6:7] offset:-384 sc1
    global_load_dword v82, v10, s[6:7] offset:896 sc1
    global_load_dword v83, v10, s[6:7] offset:2176 sc1
    global_load_dword v84, v11, s[6:7] offset:-1664 sc1
    global_load_dword v85, v11, s[6:7] offset:-384 sc1
    global_load_dword v86, v11, s[6:7] offset:896 sc1
    global_load_dword v87, v11, s[6:7] offset:2176 sc1
    global_load_dword v88, v12, s[6:7] offset:-1664 sc1
    global_load_dword v89, v12, s[6:7] offset:-384 sc1
    global_load_dword v90, v12, s[6:7] offset:896 sc1
    global_load_dword v91, v12, s[6:7] offset:2176 sc1
    global_load_dword v92, v13, s[6:7] offset:-1664 sc1
    global_load_dword v93, v13, s[6:7] offset:-384 sc1
    global_load_dword v94, v13, s[6:7] offset:896 sc1
    global_load_dword v95, v13, s[6:7] offset:2176 sc1
    global_load_dword v96, v10, s[6:7] offset:-1536 sc1
    global_load_dword v97, v10, s[6:7] offset:-256 sc1
    global_load_dword v98, v10, s[6:7] offset:1024 sc1
    global_load_dword v99, v10, s[6:7] offset:2304 sc1
    global_load_dword v100, v11, s[6:7] offset:-1536 sc1
    global_load_dword v101, v11, s[6:7] offset:-256 sc1
    global_load_dword v102, v11, s[6:7] offset:1024 sc1
    global_load_dword v103, v11, s[6:7] offset:2304 sc1
    global_load_dword v104, v12, s[6:7] offset:-1536 sc1
    global_load_dword v105, v12, s[6:7] offset:-256 sc1
    global_load_dword v106, v12, s[6:7] offset:1024 sc1
    global_load_dword v107, v12, s[6:7] offset:2304 sc1
    global_load_dword v108, v13, s[6:7] offset:-1536 sc1
    global_load_dword v109, v13, s[6:7] offset:-256 sc1
    global_load_dword v110, v13, s[6:7] offset:1024 sc1
    global_load_dword v111, v13, s[6:7] offset:2304 sc1
    s_waitcnt vmcnt(0)
    v_xor_b32 v64, v9, v64
    v_xor_b32 v65, v9, v65
    v_xor_b32 v66, v9, v66
    v_xor_b32 v67, v9, v67
    v_or3_b32 v153, v64, v65, v66
    v_xor_b32 v68, v9, v68
    v_xor_b32 v69, v9, v69
    v_or3_b32 v153, v153, v67, v68
    v_xor_b32 v70, v9, v70
    v_xor_b32 v71, v9, v71
    v_or3_b32 v153, v153, v69, v70
    v_xor_b32 v72, v9, v72
    v_xor_b32 v73, v9, v73
    v_or3_b32 v153, v153, v71, v72
    v_xor_b32 v74, v9, v74
    v_xor_b32 v75, v9, v75
    v_or3_b32 v153, v153, v73, v74
    v_xor_b32 v76, v9, v76
    v_xor_b32 v77, v9, v77
    v_or3_b32 v153, v153, v75, v76
    v_xor_b32 v78, v9, v78
    v_xor_b32 v79, v9, v79
    v_or3_b32 v153, v153, v77, v78
    v_or_b32 v153, v153, v79
    v_and_b32 v153, 0x10001, v153
    v_cmp_ne_u32 vcc, 0, v153
    s_cbranch_vccnz L_vsz2
    s_nop 1
    s_branch L_vgz2
L_vsz3:
    s_add_u32 s46, s46, 1
    s_cmp_ge_u32 s46, 0x40000
    s_cbranch_scc1 L_vgz3
    s_sleep 4
    global_load_dword v80, v10, s[6:7] offset:-1664 sc1
    global_load_dword v81, v10, s[6:7] offset:-384 sc1
    global_load_dword v82, v10, s[6:7] offset:896 sc1
    global_load_dword v83, v10, s[6:7] offset:2176 sc1
    global_load_dword v84, v11, s[6:7] offset:-1664 sc1
    global_load_dword v85, v11, s[6:7] offset:-384 sc1
    global_load_dword v86, v11, s[6:7] offset:896 sc1
    global_load_dword v87, v11, s[6:7] offset:2176 sc1
    global_load_dword v88, v12, s[6:7] offset:-1664 sc1
    global_load_dword v89, v12, s[6:7] offset:-384 sc1
    global_load_dword v90, v12, s[6:7] offset:896 sc1
    global_load_dword v91, v12, s[6:7] offset:2176 sc1
    global_load_dword v92, v13, s[6:7] offset:-1664 sc1
    global_load_dword v93, v13, s[6:7] offset:-384 sc1
    global_load_dword v94, v13, s[6:7] offset:896 sc1
    global_load_dword v95, v13, s[6:7] offset:2176 sc1
    global_load_dword v96, v10, s[6:7] offset:-1536 sc1
    global_load_dword v97, v10, s[6:7] offset:-256 sc1
    global_load_dword v98, v10, s[6:7] offset:1024 sc1
    global_load_dword v99, v10, s[6:7] offset:2304 sc1
    global_load_dword v100, v11, s[6:7] offset:-1536 sc1
    global_load_dword v101, v11, s[6:7] offset:-256 sc1
    global_load_dword v102, v11, s[6:7] offset:1024 sc1
    global_load_dword v103, v11, s[6:7] offset:2304 sc1
    global_load_dword v104, v12, s[6:7] offset:-1536 sc1
    global_load_dword v105, v12, s[6:7] offset:-256 sc1
    global_load_dword v106, v12, s[6:7] offset:1024 sc1
    global_load_dword v107, v12, s[6:7] offset:2304 sc1
    global_load_dword v108, v13, s[6:7] offset:-1536 sc1
    global_load_dword v109, v13, s[6:7] offset:-256 sc1
    global_load_dword v110, v13, s[6:7] offset:1024 sc1
    global_load_dword v111, v13, s[6:7] offset:2304 sc1
    s_waitcnt vmcnt(0)
    v_xor_b32 v80, v9, v80
    v_xor_b32 v81, v9, v81
    v_xor_b32 v82, v9, v82
    v_xor_b32 v83, v9, v83
    v_or3_b32 v153, v80, v81, v82
    v_xor_b32 v84, v9, v84
    v_xor_b32 v85, v9, v85
    v_or3_b32 v153, v153, v83, v84
    v_xor_b32 v86, v9, v86
    v_xor_b32 v87, v9, v87
    v_or3_b32 v153, v153, v85, v86
    v_xor_b32 v88, v9, v88
    v_xor_b32 v89, v9, v89
    v_or3_b32 v153, v153, v87, v88
    v_xor_b32 v90, v9, v90
    v_xor_b32 v91, v9, v91
    v_or3_b32 v153, v153, v89, v90
    v_xor_b32 v92, v9, v92
    v_xor_b32 v93, v9, v93
    v_or3_b32 v153, v153, v91, v92
    v_xor_b32 v94, v9, v94
    v_xor_b32 v95, v9, v95
    v_or3_b32 v153, v153, v93, v94
    v_or_b32 v153, v153, v95
    v_and_b32 v153, 0x10001, v153
    v_cmp_ne_u32 vcc, 0, v153
    s_cbranch_vccnz L_vsz3
    s_nop 1
    s_branch L_vgz3
L_vsz4:
    s_add_u32 s46, s46, 1
    s_cmp_ge_u32 s46, 0x40000
    s_cbranch_scc1 L_vgz4
    s_sleep 4
    global_load_dword v96, v10, s[6:7] offset:-1536 sc1
    global_load_dword v97, v10, s[6:7] offset:-256 sc1
    global_load_dword v98, v10, s[6:7] offset:1024 sc1
    global_load_dword v99, v10, s[6:7] offset:2304 sc1
    global_load_dword v100, v11, s[6:7] offset:-1536 sc1
    global_load_dword v101, v11, s[6:7] offset:-256 sc1
    global_load_dword v102, v11, s[6:7] offset:1024 sc1
    global_load_dword v103, v11, s[6:7] offset:2304 sc1
    global_load_dword v104, v12, s[6:7] offset:-1536 sc1
    global_load_dword v105, v12, s[6:7] offset:-256 sc1
    global_load_dword v106, v12, s[6:7] offset:1024 sc1
    global_load_dword v107, v12, s[6:7] offset:2304 sc1
    global_load_dword v108, v13, s[6:7] offset:-1536 sc1
    global_load_dword v109, v13, s[6:7] offset:-256 sc1
    global_load_dword v110, v13, s[6:7] offset:1024 sc1
    global_load_dword v111, v13, s[6:7] offset:2304 sc1
    s_waitcnt vmcnt(0)
    v_xor_b32 v96, v9, v96
    v_xor_b32 v97, v9, v97
    v_xor_b32 v98, v9, v98
    v_xor_b32 v99, v9, v99
    v_or3_b32 v153, v96, v97, v98
    v_xor_b32 v100, v9, v100
    v_xor_b32 v101, v9, v101
    v_or3_b32 v153, v153, v99, v100
    v_xor_b32 v102, v9, v102
    v_xor_b32 v103, v9, v103
    v_or3_b32 v153, v153, v101, v102
    v_xor_b32 v104, v9, v104
    v_xor_b32 v105, v9, v105
    v_or3_b32 v153, v153, v103, v104
    v_xor_b32 v106, v9, v106
    v_xor_b32 v107, v9, v107
    v_or3_b32 v153, v153, v105, v106
    v_xor_b32 v108, v9, v108
    v_xor_b32 v109, v9, v109
    v_or3_b32 v153, v153, v107, v108
    v_xor_b32 v110, v9, v110
    v_xor_b32 v111, v9, v111
    v_or3_b32 v153, v153, v109, v110
    v_or_b32 v153, v153, v111
    v_and_b32 v153, 0x10001, v153
    v_cmp_ne_u32 vcc, 0, v153
    s_cbranch_vccnz L_vsz4
    s_nop 1
    s_branch L_vgz4
L_vsr0:
    s_add_u32 s46, s46, 1
    s_cmp_ge_u32 s46, 0x40000
    s_cbranch_scc1 L_vgr0
    s_sleep 4
    buffer_load_dwordx4 v[200:203], v13, s[64:67], s4 offen offset:0 sc1
    buffer_load_dwordx4 v[204:207], v14, s[64:67], s4 offen offset:0 sc1
    buffer_load_dwordx4 v[208:211], v13, s[64:67], s5 offen offset:0 sc1
    buffer_load_dwordx4 v[212:215], v14, s[64:67], s5 offen offset:0 sc1
    buffer_load_dwordx4 v[216:219], v13, s[64:67], s15 offen offset:0 sc1
    buffer_load_dwordx4 v[220:223], v14, s[64:67], s15 offen offset:0 sc1
    buffer_load_dwordx4 v[104:107], v13, s[64:67], s16 offen offset:0 sc1
    buffer_load_dwordx4 v[108:111], v14, s[64:67], s16 offen offset:0 sc1
    buffer_load_dwordx4 v[112:115], v13, s[64:67], s17 offen offset:0 sc1
    buffer_load_dwordx4 v[116:119], v14, s[64:67], s17 offen offset:0 sc1
    buffer_load_dwordx4 v[120:123], v13, s[64:67], s43 offen offset:0 sc1
    s_waitcnt vmcnt(0)
    v_xor_b32 v200, v11, v200
    v_xor_b32 v203, v12, v203
    v_xor_b32 v204, v11, v204
    v_xor_b32 v207, v12, v207
    v_or3_b32 v21, v200, v203, v204
    v_or_b32 v21, v21, v207
    v_and_b32 v21, 0x80008000, v21
    v_cmp_ne_u32 vcc, 0, v21
    s_cbranch_vccnz L_vsr0
    s_nop 1
    s_branch L_vgr0
L_vsr1:
    s_add_u32 s46, s46, 1
    s_cmp_ge_u32 s46, 0x40000
    s_cbranch_scc1 L_vgr1
    s_sleep 4
    buffer_load_dwordx4 v[208:211], v13, s[64:67], s5 offen offset:0 sc1
    buffer_load_dwordx4 v[212:215], v14, s[64:67], s5 offen offset:0 sc1
    buffer_load_dwordx4 v[216:219], v13, s[64:67], s15 offen offset:0 sc1
    buffer_load_dwordx4 v[220:223], v14, s[64:67], s15 offen offset:0 sc1
    buffer_load_dwordx4 v[104:107], v13, s[64:67], s16 offen offset:0 sc1
    buffer_load_dwordx4 v[108:111], v14, s[64:67], s16 offen offset:0 sc1
    buffer_load_dwordx4 v[112:115], v13, s[64:67], s17 offen offset:0 sc1
    buffer_load_dwordx4 v[116:119], v14, s[64:67], s17 offen offset:0 sc1
    buffer_load_dwordx4 v[120:123], v13, s[64:67], s43 offen offset:0 sc1
    buffer_load_dwordx4 v[124:127], v14, s[64:67], s43 offen offset:0 sc1
    buffer_load_dwordx4 v[128:131], v13, s[64:67], s56 offen offset:0 sc1
    buffer_load_dwordx4 v[132:135], v14, s[64:67], s56 offen offset:0 sc1
    buffer_load_dwordx4 v[136:139], v13, s[64:67], s57 offen offset:0 sc1
    buffer_load_dwordx4 v[160:163], v14, s[64:67], s57 offen offset:0 sc1
    buffer_load_dwordx4 v[164:167], v13, s[64:67], s58 offen offset:0 sc1
    s_waitcnt vmcnt(0)
    v_xor_b32 v208, v11, v208
    v_xor_b32 v211, v12, v211
    v_xor_b32 v212, v11, v212
    v_xor_b32 v215, v12, v215
    v_or3_b32 v21, v208, v211, v212
    v_xor_b32 v216, v11, v216
    v_xor_b32 v219, v12, v219
    v_or3_b32 v21, v21, v215, v216
    v_xor_b32 v220, v11, v220
    v_xor_b32 v223, v12, v223
    v_or3_b32 v21, v21, v219, v220
    v_or_b32 v21, v21, v223
    v_and_b32 v21, 0x80008000, v21
    v_cmp_ne_u32 vcc, 0, v21
    s_cbranch_vccnz L_vsr1
    s_nop 1
    s_branch L_vgr1
L_vsr2:
    s_add_u32 s46, s46, 1
    s_cmp_ge_u32 s46, 0x40000
    s_cbranch_scc1 L_vgr2
    s_sleep 4
    buffer_load_dwordx4 v[104:107], v13, s[64:67], s16 offen offset:0 sc1
    buffer_load_dwordx4 v[108:111], v14, s[64:67], s16 offen offset:0 sc1
    buffer_load_dwordx4 v[112:115], v13, s[64:67], s17 offen offset:0 sc1
    buffer_load_dwordx4 v[116:119], v14, s[64:67], s17 offen offset:0 sc1
    buffer_load_dwordx4 v[120:123], v13, s[64:67], s43 offen offset:0 sc1
    buffer_load_dwordx4 v[124:127], v14, s[64:67], s43 offen offset:0 sc1
    buffer_load_dwordx4 v[128:131], v13, s[64:67], s56 offen offset:0 sc1
    buffer_load_dwordx4 v[132:135], v14, s[64:67], s56 offen offset:0 sc1
    buffer_load_dwordx4 v[136:139], v13, s[64:67], s57 offen offset:0 sc1
    buffer_load_dwordx4 v[160:163], v14, s[64:67], s57 offen offset:0 sc1
    buffer_load_dwordx4 v[164:167], v13, s[64:67], s58 offen offset:0 sc1
    buffer_load_dwordx4 v[168:171], v14, s[64:67], s58 offen offset:0 sc1
    s_waitcnt vmcnt(0)
    v_xor_b32 v104, v11, v104
    v_xor_b32 v107, v12, v107
    v_xor_b32 v108, v11, v108
    v_xor_b32 v111, v12, v111
    v_or3_b32 v21, v104, v107, v108
    v_xor_b32 v112, v11, v112
    v_xor_b32 v115, v12, v115
    v_or3_b32 v21, v21, v111, v112
    v_xor_b32 v116, v11, v116
    v_xor_b32 v119, v12, v119
    v_or3_b32 v21, v21, v115, v116
    v_or_b32 v21, v21, v119
    v_and_b32 v21, 0x80008000, v21
    v_cmp_ne_u32 vcc, 0, v21
    s_cbranch_vccnz L_vsr2
    s_nop 1
    s_branch L_vgr2
L_vsr3:
    s_add_u32 s46, s46, 1
    s_cmp_ge_u32 s46, 0x40000
    s_cbranch_scc1 L_vgr3
    s_sleep 4
    buffer_load_dwordx4 v[120:123], v13, s[64:67], s43 offen offset:0 sc1
    buffer_load_dwordx4 v[124:127], v14, s[64:67], s43 offen offset:0 sc1
    buffer_load_dwordx4 v[128:131], v13, s[64:67], s56 offen offset:0 sc1
    buffer_load_dwordx4 v[132:135], v14, s[64:67], s56 offen offset:0 sc1
    buffer_load_dwordx4 v[136:139], v13, s[64:67], s57 offen offset:0 sc1
    buffer_load_dwordx4 v[160:163], v14, s[64:67], s57 offen offset:0 sc1
    buffer_load_dwordx4 v[164:167], v13, s[64:67], s58 offen offset:0 sc1
    buffer_load_dwordx4 v[168:171], v14, s[64:67], s58 offen offset:0 sc1
    s_waitcnt vmcnt(0)
    v_xor_b32 v120, v11, v120
    v_xor_b32 v123, v12, v123
    v_xor_b32 v124, v11, v124
    v_xor_b32 v127, v12, v127
    v_or3_b32 v21, v120, v123, v124
    v_xor_b32 v128, v11, v128
    v_xor_b32 v131, v12, v131
    v_or3_b32 v21, v21, v127, v128
    v_xor_b32 v132, v11, v132
    v_xor_b32 v135, v12, v135
    v_or3_b32 v21, v21, v131, v132
    v_or_b32 v21, v21, v135
    v_and_b32 v21, 0x80008000, v21
    v_cmp_ne_u32 vcc, 0, v21
    s_cbranch_vccnz L_vsr3
    s_nop 1
    s_branch L_vgr3
L_vsr4:
    s_add_u32 s46, s46, 1
    s_cmp_ge_u32 s46, 0x40000
    s_cbranch_scc1 L_vgr4
    s_sleep 4
    buffer_load_dwordx4 v[136:139], v13, s[64:67], s57 offen offset:0 sc1
    buffer_load_dwordx4 v[160:163], v14, s[64:67], s57 offen offset:0 sc1
    buffer_load_dwordx4 v[164:167], v13, s[64:67], s58 offen offset:0 sc1
    buffer_load_dwordx4 v[168:171], v14, s[64:67], s58 offen offset:0 sc1
    buffer_load_dwordx4 v[172:175], v13, s[64:67], s59 offen offset:0 sc1
    buffer_load_dwordx4 v[176:179], v14, s[64:67], s59 offen offset:0 sc1
    buffer_load_dwordx4 v[180:183], v13, s[64:67], s73 offen offset:0 sc1
    buffer_load_dwordx4 v[184:187], v14, s[64:67], s73 offen offset:0 sc1
    buffer_load_dwordx4 v[188:191], v13, s[64:67], s4 offen offset:2048 sc1
    s_waitcnt vmcnt(0)
    v_xor_b32 v136, v11, v136
    v_xor_b32 v139, v12, v139
    v_xor_b32 v160, v11, v160
    v_xor_b32 v163, v12, v163
    v_or3_b32 v21, v136, v139, v160
    v_xor_b32 v164, v11, v164
    v_xor_b32 v167, v12, v167
    v_or3_b32 v21, v21, v163, v164
    v_xor_b32 v168, v11, v168
    v_xor_b32 v171, v12, v171
    v_or3_b32 v21, v21, v167, v168
    v_or_b32 v21, v21, v171
    v_and_b32 v21, 0x80008000, v21
    v_cmp_ne_u32 vcc, 0, v21
    s_cbranch_vccnz L_vsr4
    s_nop 1
    s_branch L_vgr4
L_vsr5:
    s_add_u32 s46, s46, 1
    s_cmp_ge_u32 s46, 0x40000
    s_cbranch_scc1 L_vgr5
    s_sleep 4
    buffer_load_dwordx4 v[172:175], v13, s[64:67], s59 offen offset:0 sc1
    buffer_load_dwordx4 v[176:179], v14, s[64:67], s59 offen offset:0 sc1
    buffer_load_dwordx4 v[180:183], v13, s[64:67], s73 offen offset:0 sc1
    buffer_load_dwordx4 v[184:187], v14, s[64:67], s73 offen offset:0 sc1
    buffer_load_dwordx4 v[188:191], v13, s[64:67], s4 offen offset:2048 sc1
    buffer_load_dwordx4 v[104:107], v14, s[64:67], s4 offen offset:2048 sc1
    buffer_load_dwordx4 v[108:111], v13, s[64:67], s5 offen offset:2048 sc1
    buffer_load_dwordx4 v[112:115], v14, s[64:67], s5 offen offset:2048 sc1
    buffer_load_dwordx4 v[116:119], v13, s[64:67], s15 offen offset:2048 sc1
    buffer_load_dwordx4 v[120:123], v14, s[64:67], s15 offen offset:2048 sc1
    s_waitcnt vmcnt(0)
    v_xor_b32 v172, v11, v172
    v_xor_b32 v175, v12, v175
    v_xor_b32 v176, v11, v176
    v_xor_b32 v179, v12, v179
    v_or3_b32 v21, v172, v175, v176
    v_xor_b32 v180, v11, v180
    v_xor_b32 v183, v12, v183
    v_or3_b32 v21, v21, v179, v180
    v_xor_b32 v184, v11, v184
    v_xor_b32 v187, v12, v187
    v_or3_b32 v21, v21, v183, v184
    v_or_b32 v21, v21, v187
    v_and_b32 v21, 0x80008000, v21
    v_cmp_ne_u32 vcc, 0, v21
    s_cbranch_vccnz L_vsr5
    s_nop 1
    s_branch L_vgr5
L_vsr6:
    s_add_u32 s46, s46, 1
    s_cmp_ge_u32 s46, 0x40000
    s_cbranch_scc1 L_vgr6
    s_sleep 4
    buffer_load_dwordx4 v[188:191], v13, s[64:67], s4 offen offset:2048 sc1
    buffer_load_dwordx4 v[104:107], v14, s[64:67], s4 offen offset:2048 sc1
    buffer_load_dwordx4 v[108:111], v13, s[64:67], s5 offen offset:2048 sc1
    buffer_load_dwordx4 v[112:115], v14, s[64:67], s5 offen offset:2048 sc1
    buffer_load_dwordx4 v[116:119], v13, s[64:67], s15 offen offset:2048 sc1
    buffer_load_dwordx4 v[120:123], v14, s[64:67], s15 offen offset:2048 sc1
    s_waitcnt vmcnt(0)
    v_xor_b32 v188, v11, v188
    v_xor_b32 v191, v12, v191
    v_xor_b32 v104, v11, v104
    v_xor_b32 v107, v12, v107
    v_or3_b32 v21, v188, v191, v104
    v_or_b32 v21, v21, v107
    v_and_b32 v21, 0x80008000, v21
    v_cmp_ne_u32 vcc, 0, v21
    s_cbranch_vccnz L_vsr6
    s_nop 1
    s_branch L_vgr6
L_vsr7:
    s_add_u32 s46, s46, 1
    s_cmp_ge_u32 s46, 0x40000
    s_cbranch_scc1 L_vgr7
    s_sleep 4
    buffer_load_dwordx4 v[108:111], v13, s[64:67], s5 offen offset:2048 sc1
    buffer_load_dwordx4 v[112:115], v14, s[64:67], s5 offen offset:2048 sc1
    buffer_load_dwordx4 v[116:119], v13, s[64:67], s15 offen offset:2048 sc1
    buffer_load_dwordx4 v[120:123], v14, s[64:67], s15 offen offset:2048 sc1
    buffer_load_dwordx4 v[124:127], v13, s[64:67], s74 offen offset:0 sc1
    buffer_load_dwordx4 v[128:131], v13, s[64:67], s75 offen offset:0 sc1
    buffer_load_dwordx4 v[132:135], v14, s[64:67], s74 offen offset:0 sc1
    buffer_load_dwordx4 v[136:139], v14, s[64:67], s75 offen offset:0 sc1
    buffer_load_dwordx4 v[160:163], v13, s[64:67], s16 offen offset:2048 sc1
    buffer_load_dwordx4 v[164:167], v14, s[64:67], s16 offen offset:2048 sc1
    buffer_load_dwordx4 v[168:171], v13, s[64:67], s17 offen offset:2048 sc1
    s_waitcnt vmcnt(0)
    v_xor_b32 v108, v11, v108
    v_xor_b32 v111, v12, v111
    v_xor_b32 v112, v11, v112
    v_xor_b32 v115, v12, v115
    v_or3_b32 v21, v108, v111, v112
    v_xor_b32 v116, v11, v116
    v_xor_b32 v119, v12, v119
    v_or3_b32 v21, v21, v115, v116
    v_xor_b32 v120, v11, v120
    v_xor_b32 v123, v12, v123
    v_or3_b32 v21, v21, v119, v120
    v_or_b32 v21, v21, v123
    v_and_b32 v21, 0x80008000, v21
    v_cmp_ne_u32 vcc, 0, v21
    s_cbranch_vccnz L_vsr7
    s_nop 1
    s_branch L_vgr7
L_vsr8:
    s_add_u32 s46, s46, 1
    s_cmp_ge_u32 s46, 0x40000
    s_cbranch_scc1 L_vgr8
    s_sleep 4
    buffer_load_dwordx4 v[124:127], v13, s[64:67], s74 offen offset:0 sc1
    buffer_load_dwordx4 v[128:131], v13, s[64:67], s75 offen offset:0 sc1
    buffer_load_dwordx4 v[132:135], v14, s[64:67], s74 offen offset:0 sc1
    buffer_load_dwordx4 v[136:139], v14, s[64:67], s75 offen offset:0 sc1
    buffer_load_dwordx4 v[160:163], v13, s[64:67], s16 offen offset:2048 sc1
    buffer_load_dwordx4 v[164:167], v14, s[64:67], s16 offen offset:2048 sc1
    buffer_load_dwordx4 v[168:171], v13, s[64:67], s17 offen offset:2048 sc1
    buffer_load_dwordx4 v[172:175], v14, s[64:67], s17 offen offset:2048 sc1
    buffer_load_dwordx4 v[176:179], v13, s[64:67], s43 offen offset:2048 sc1
    buffer_load_dwordx4 v[180:183], v14, s[64:67], s43 offen offset:2048 sc1
    buffer_load_dwordx4 v[184:187], v13, s[64:67], s56 offen offset:2048 sc1
    buffer_load_dwordx4 v[140:143], v14, s[64:67], s56 offen offset:2048 sc1
    buffer_load_dwordx4 v[144:147], v13, s[64:67], s57 offen offset:2048 sc1
    buffer_load_dwordx4 v[148:151], v14, s[64:67], s57 offen offset:2048 sc1
    s_waitcnt vmcnt(0)
    v_xor_b32 v124, v5, v124
    v_xor_b32 v127, v6, v127
    v_xor_b32 v128, v5, v128
    v_xor_b32 v131, v6, v131
    v_or3_b32 v21, v124, v127, v128
    v_xor_b32 v132, v5, v132
    v_xor_b32 v135, v6, v135
    v_or3_b32 v21, v21, v131, v132
    v_xor_b32 v136, v5, v136
    v_xor_b32 v139, v6, v139
    v_or3_b32 v21, v21, v135, v136
    v_or_b32 v21, v21, v139
    v_and_b32 v21, 0x80008000, v21
    v_cmp_ne_u32 vcc, 0, v21
    s_cbranch_vccnz L_vsr8
    s_nop 1
    s_branch L_vgr8
L_vsr9:
    s_add_u32 s46, s46, 1
    s_cmp_ge_u32 s46, 0x40000
    s_cbranch_scc1 L_vgr9
    s_sleep 4
    buffer_load_dwordx4 v[160:163], v13, s[64:67], s16 offen offset:2048 sc1
    buffer_load_dwordx4 v[164:167], v14, s[64:67], s16 offen offset:2048 sc1
    buffer_load_dwordx4 v[168:171], v13, s[64:67], s17 offen offset:2048 sc1
    buffer_load_dwordx4 v[172:175], v14, s[64:67], s17 offen offset:2048 sc1
    buffer_load_dwordx4 v[176:179], v13, s[64:67], s43 offen offset:2048 sc1
    buffer_load_dwordx4 v[180:183], v14, s[64:67], s43 offen offset:2048 sc1
    buffer_load_dwordx4 v[184:187], v13, s[64:67], s56 offen offset:2048 sc1
    buffer_load_dwordx4 v[140:143], v14, s[64:67], s56 offen offset:2048 sc1
    buffer_load_dwordx4 v[144:147], v13, s[64:67], s57 offen offset:2048 sc1
    buffer_load_dwordx4 v[148:151], v14, s[64:67], s57 offen offset:2048 sc1
    buffer_load_dwordx4 v[152:155], v13, s[64:67], s58 offen offset:2048 sc1
    buffer_load_dwordx4 v[156:159], v14, s[64:67], s58 offen offset:2048 sc1
    buffer_load_dwordx4 v[188:191], v13, s[64:67], s59 offen offset:2048 sc1
    buffer_load_dwordx4 v[104:107], v14, s[64:67], s59 offen offset:2048 sc1
    buffer_load_dwordx4 v[108:111], v13, s[64:67], s73 offen offset:2048 sc1
    buffer_load_dwordx4 v[112:115], v14, s[64:67], s73 offen offset:2048 sc1
    buffer_load_dwordx4 v[116:119], v13, s[64:67], s74 offen offset:2048 sc1
    s_waitcnt vmcnt(0)
    v_xor_b32 v160, v11, v160
    v_xor_b32 v163, v12, v163
    v_xor_b32 v164, v11, v164
    v_xor_b32 v167, v12, v167
    v_or3_b32 v21, v160, v163, v164
    v_xor_b32 v168, v11, v168
    v_xor_b32 v171, v12, v171
    v_or3_b32 v21, v21, v167, v168
    v_xor_b32 v172, v11, v172
    v_xor_b32 v175, v12, v175
    v_or3_b32 v21, v21, v171, v172
    v_or_b32 v21, v21, v175
    v_and_b32 v21, 0x80008000, v21
    v_cmp_ne_u32 vcc, 0, v21
    s_cbranch_vccnz L_vsr9
    s_nop 1
    s_branch L_vgr9
L_vsr10:
    s_add_u32 s46, s46, 1
    s_cmp_ge_u32 s46, 0x40000
    s_cbranch_scc1 L_vgr10
    s_sleep 4
    buffer_load_dwordx4 v[176:179], v13, s[64:67], s43 offen offset:2048 sc1
    buffer_load_dwordx4 v[180:183], v14, s[64:67], s43 offen offset:2048 sc1
    buffer_load_dwordx4 v[184:187], v13, s[64:67], s56 offen offset:2048 sc1
    buffer_load_dwordx4 v[140:143], v14, s[64:67], s56 offen offset:2048 sc1
    buffer_load_dwordx4 v[144:147], v13, s[64:67], s57 offen offset:2048 sc1
    buffer_load_dwordx4 v[148:151], v14, s[64:67], s57 offen offset:2048 sc1
    buffer_load_dwordx4 v[152:155], v13, s[64:67], s58 offen offset:2048 sc1
    buffer_load_dwordx4 v[156:159], v14, s[64:67], s58 offen offset:2048 sc1
    buffer_load_dwordx4 v[188:191], v13, s[64:67], s59 offen offset:2048 sc1
    buffer_load_dwordx4 v[104:107], v14, s[64:67], s59 offen offset:2048 sc1
    buffer_load_dwordx4 v[108:111], v13, s[64:67], s73 offen offset:2048 sc1
    buffer_load_dwordx4 v[112:115], v14, s[64:67], s73 offen offset:2048 sc1
    buffer_load_dwordx4 v[116:119], v13, s[64:67], s74 offen offset:2048 sc1
    buffer_load_dwordx4 v[120:123], v13, s[64:67], s75 offen offset:2048 sc1
    buffer_load_dwordx4 v[124:127], v14, s[64:67], s74 offen offset:2048 sc1
    buffer_load_dwordx4 v[128:131], v14, s[64:67], s75 offen offset:2048 sc1
    s_waitcnt vmcnt(0)
    v_xor_b32 v176, v11, v176
    v_xor_b32 v179, v12, v179
    v_xor_b32 v180, v11, v180
    v_xor_b32 v183, v12, v183
    v_or3_b32 v21, v176, v179, v180
    v_xor_b32 v184, v11, v184
    v_xor_b32 v187, v12, v187
    v_or3_b32 v21, v21, v183, v184
    v_xor_b32 v140, v11, v140
    v_xor_b32 v143, v12, v143
    v_or3_b32 v21, v21, v187, v140
    v_or_b32 v21, v21, v143
    v_and_b32 v21, 0x80008000, v21
    v_cmp_ne_u32 vcc, 0, v21
    s_cbranch_vccnz L_vsr10
    s_nop 1
    s_branch L_vgr10
L_vsr11:
    s_add_u32 s46, s46, 1
    s_cmp_ge_u32 s46, 0x40000
    s_cbranch_scc1 L_vgr11
    s_sleep 4
    buffer_load_dwordx4 v[144:147], v13, s[64:67], s57 offen offset:2048 sc1
    buffer_load_dwordx4 v[148:151], v14, s[64:67], s57 offen offset:2048 sc1
    buffer_load_dwordx4 v[152:155], v13, s[64:67], s58 offen offset:2048 sc1
    buffer_load_dwordx4 v[156:159], v14, s[64:67], s58 offen offset:2048 sc1
    buffer_load_dwordx4 v[188:191], v13, s[64:67], s59 offen offset:2048 sc1
    buffer_load_dwordx4 v[104:107], v14, s[64:67], s59 offen offset:2048 sc1
    buffer_load_dwordx4 v[108:111], v13, s[64:67], s73 offen offset:2048 sc1
    buffer_load_dwordx4 v[112:115], v14, s[64:67], s73 offen offset:2048 sc1
    buffer_load_dwordx4 v[116:119], v13, s[64:67], s74 offen offset:2048 sc1
    buffer_load_dwordx4 v[120:123], v13, s[64:67], s75 offen offset:2048 sc1
    buffer_load_dwordx4 v[124:127], v14, s[64:67], s74 offen offset:2048 sc1
    buffer_load_dwordx4 v[128:131], v14, s[64:67], s75 offen offset:2048 sc1
    s_waitcnt vmcnt(0)
    v_xor_b32 v144, v11, v144
    v_xor_b32 v147, v12, v147
    v_xor_b32 v148, v11, v148
    v_xor_b32 v151, v12, v151
    v_or3_b32 v21, v144, v147, v148
    v_xor_b32 v152, v11, v152
    v_xor_b32 v155, v12, v155
    v_or3_b32 v21, v21, v151, v152
    v_xor_b32 v156, v11, v156
    v_xor_b32 v159, v12, v159
    v_or3_b32 v21, v21, v155, v156
    v_or_b32 v21, v21, v159
    v_and_b32 v21, 0x80008000, v21
    v_cmp_ne_u32 vcc, 0, v21
    s_cbranch_vccnz L_vsr11
    s_nop 1
    s_branch L_vgr11
L_vsr12:
    s_add_u32 s46, s46, 1
    s_cmp_ge_u32 s46, 0x40000
    s_cbranch_scc1 L_vgr12
    s_sleep 4
    buffer_load_dwordx4 v[188:191], v13, s[64:67], s59 offen offset:2048 sc1
    buffer_load_dwordx4 v[104:107], v14, s[64:67], s59 offen offset:2048 sc1
    buffer_load_dwordx4 v[108:111], v13, s[64:67], s73 offen offset:2048 sc1
    buffer_load_dwordx4 v[112:115], v14, s[64:67], s73 offen offset:2048 sc1
    buffer_load_dwordx4 v[116:119], v13, s[64:67], s74 offen offset:2048 sc1
    buffer_load_dwordx4 v[120:123], v13, s[64:67], s75 offen offset:2048 sc1
    buffer_load_dwordx4 v[124:127], v14, s[64:67], s74 offen offset:2048 sc1
    buffer_load_dwordx4 v[128:131], v14, s[64:67], s75 offen offset:2048 sc1
    s_waitcnt vmcnt(0)
    v_xor_b32 v188, v11, v188
    v_xor_b32 v191, v12, v191
    v_xor_b32 v104, v11, v104
    v_xor_b32 v107, v12, v107
    v_or3_b32 v21, v188, v191, v104
    v_xor_b32 v108, v11, v108
    v_xor_b32 v111, v12, v111
    v_or3_b32 v21, v21, v107, v108
    v_xor_b32 v112, v11, v112
    v_xor_b32 v115, v12, v115
    v_or3_b32 v21, v21, v111, v112
    v_or_b32 v21, v21, v115
    v_and_b32 v21, 0x80008000, v21
    v_cmp_ne_u32 vcc, 0, v21
    s_cbranch_vccnz L_vsr12
    s_nop 1
    s_branch L_vgr12
L_vsr13:
    s_add_u32 s46, s46, 1
    s_cmp_ge_u32 s46, 0x40000
    s_cbranch_scc1 L_vgr13
    s_sleep 4
    buffer_load_dwordx4 v[116:119], v13, s[64:67], s74 offen offset:2048 sc1
    buffer_load_dwordx4 v[120:123], v13, s[64:67], s75 offen offset:2048 sc1
    buffer_load_dwordx4 v[124:127], v14, s[64:67], s74 offen offset:2048 sc1
    buffer_load_dwordx4 v[128:131], v14, s[64:67], s75 offen offset:2048 sc1
    s_waitcnt vmcnt(0)
    v_xor_b32 v116, v5, v116
    v_xor_b32 v119, v6, v119
    v_xor_b32 v120, v5, v120
    v_xor_b32 v123, v6, v123
    v_or3_b32 v21, v116, v119, v120
    v_xor_b32 v124, v5, v124
    v_xor_b32 v127, v6, v127
    v_or3_b32 v21, v21, v123, v124
    v_xor_b32 v128, v5, v128
    v_xor_b32 v131, v6, v131
    v_or3_b32 v21, v21, v127, v128
    v_or_b32 v21, v21, v131
    v_and_b32 v21, 0x80008000, v21
    v_cmp_ne_u32 vcc, 0, v21
    s_cbranch_vccnz L_vsr13
    s_nop 1
    s_branch L_vgr13
.fill 1024, 4, 0xbf810000
L_text_end:
.section .rodata,"a"
.p2align 6
.amdhsa_kernel sequential_preLN__spectral_fnet__dense_activation_squared_relu__prompt_kernel
  .amdhsa_next_free_vgpr 512
  .amdhsa_next_free_sgpr 102
  .amdhsa_accum_offset 256
  .amdhsa_group_segment_fixed_size 0
  .amdhsa_kernarg_size 104
  .amdhsa_user_sgpr_count 2
  .amdhsa_user_sgpr_kernarg_segment_ptr 1
  .amdhsa_system_sgpr_workgroup_id_x 1
  .amdhsa_float_denorm_mode_32 3
.end_amdhsa_kernel
```
